```python
import torch

def _softmax(x, axis=-1):
    return torch.softmax(x, dim=axis)
def _gelu(x):
    return torch.nn.functional.gelu(x, approximate="tanh")
def _silu(x):
    return torch.nn.functional.silu(x)
def _sigmoid(x):
    return torch.sigmoid(x)
def _layernorm(x, axis=-1, eps=1e-5):
    m = x.mean(dim=axis, keepdim=True)
    v = x.var(dim=axis, keepdim=True, unbiased=False)
    return (x - m) / torch.sqrt(v + eps)
def _scatter_add(tgt, idx, src, axis=0):
    return tgt.clone().index_add_(axis, idx, src)
def _segment_sum(src, seg, n):
    out = torch.zeros((n,) + src.shape[1:], dtype=src.dtype)
    return out.index_add_(0, seg, src)
def _pad(x, pw):
    flat = tuple(v for pair in reversed(pw) for v in pair)
    return torch.nn.functional.pad(x, flat)

kernel_name = 'standalone__edge_featured_mpnn_gatedgcn__graph'

def setup_inputs():

    _w = (lambda a: (lambda t: t.to(torch.bfloat16) if t.is_floating_point() else t)(torch.as_tensor(a)))
    N, deg, D, De = 10000, 16, 256, max(16, 1)
    E = N * deg
    return {
        "x": _w((lambda *s: torch.randn(*s, dtype=torch.bfloat16) * 0.4)(N, D)),
        "e_attr": _w((lambda *s: torch.randn(*s, dtype=torch.bfloat16) * 0.4)(E, De)),
        "src": _w((lambda lo, hi, *s: torch.randint(lo, hi, s))(0, N, E).to(torch.int64)),
        "dst": _w((lambda lo, hi, *s: torch.randint(lo, hi, s))(0, N, E).to(torch.int64)),
        "w_a": _w((lambda *s: torch.randn(*s, dtype=torch.bfloat16) * 0.4)(D, D)),
        "w_b": _w((lambda *s: torch.randn(*s, dtype=torch.bfloat16) * 0.4)(D, D)),
        "w_c": _w((lambda *s: torch.randn(*s, dtype=torch.bfloat16) * 0.4)(De, D)),
        "w_u": _w((lambda *s: torch.randn(*s, dtype=torch.bfloat16) * 0.05)(D, D)),
        "w_v": _w((lambda *s: torch.randn(*s, dtype=torch.bfloat16) * 0.05)(D, D)),
    }

def reference(x, e_attr, src, dst, w_a, w_b, w_c, w_u, w_v):
    N, D = x.shape
    hv = x @ w_v
    g = x[dst] @ w_a + x[src] @ w_b + e_attr @ w_c
    eta = _sigmoid(g)
    denom = _segment_sum(eta, dst, N) + 1e-6
    eta_n = eta / denom[dst]
    agg = _segment_sum(eta_n * hv[src], dst, N)
    z = x @ w_u + agg
    relu_z = torch.where(z > 0, z, 0 * z)
    return x + relu_z
```

```asm
; @launch kernel=k1_kernel grid=(256,1,1) block=(512,1,1) lds=131072
; @launch kernel=standalone__edge_featured_mpnn_gatedgcn__graph_kernel grid=(256,1,1) block=(1024,1,1) lds=152576
.amdgcn_target "amdgcn-amd-amdhsa--gfx950"
.text
.globl k1_kernel
.p2align 8
.type k1_kernel,@function
k1_kernel:
    s_cmp_ge_u32 s2, 256
    s_cbranch_scc1 K1_END
    s_cmp_lt_u32 s2, 16
    s_cbranch_scc0 K1_NOCPF
    s_getpc_b64 s[4:5]
K1_PFB:
    v_lshlrev_b32 v2, 7, v0
    v_mov_b32 v3, s5
    v_add_co_u32 v2, vcc, s4, v2
    s_mov_b32 s6, (K2_CODE_END-K1_PFB)/128
    v_addc_co_u32 v3, vcc, 0, v3, vcc
    v_cmp_gt_u32 vcc, s6, v0
    s_and_saveexec_b64 s[4:5], vcc
    global_load_dword v100, v[2:3], off
    s_mov_b64 exec, s[4:5]
K1_NOCPF:
    s_cmp_lt_u32 s2, 64
    s_cbranch_scc1 K1_SORT
    s_load_dwordx2 s[24:25], s[0:1], 0
    s_load_dwordx4 s[28:31], s[0:1], 32
    s_load_dwordx4 s[32:35], s[0:1], 56
    s_load_dwordx2 s[26:27], s[0:1], 88
    s_sub_u32 s3, s2, 64
    s_and_b32 s4, s3, 7
    s_lshr_b32 s5, s3, 3
    s_mul_i32 s6, s5, 43
    s_lshr_b32 s6, s6, 7
    s_mul_i32 s7, s6, 3
    s_sub_u32 s7, s5, s7
    s_mul_i32 s4, s4, 3
    s_add_u32 s4, s4, s7
    s_mul_i32 s36, s4, 13
    s_cmp_eq_u32 s4, 23
    s_cselect_b32 s37, 14, 13
    s_lshr_b32 s38, s6, 2
    s_and_b32 s39, s6, 3
    v_and_b32 v1, 63, v0
    v_lshrrev_b32 v2, 6, v0
    s_nop 0
    v_readfirstlane_b32 s40, v2
    s_nop 3
    s_and_b32 s41, s40, 1
    s_lshr_b32 s42, s40, 1
    v_lshrrev_b32 v2, 2, v1
    v_and_b32 v3, 3, v1
    v_lshlrev_b32 v4, 9, v2
    v_lshl_add_u32 v4, v3, 4, v4
    v_lshrrev_b32 v2, 5, v1
    v_lshlrev_b32 v6, 9, v2
    v_bfe_u32 v3, v1, 2, 2
    v_lshl_add_u32 v6, v3, 6, v6
    v_bfe_u32 v3, v1, 4, 1
    v_lshl_add_u32 v6, v3, 5, v6
    v_and_b32 v3, 3, v1
    v_lshl_add_u32 v6, v3, 3, v6
    s_lshl_b32 s43, s41, 14
    s_add_u32 s43, s43, 65536
    v_add_u32 v6, s43, v6
    v_lshrrev_b32 v2, 5, v1
    v_and_b32 v3, 31, v1
    v_add_u32 v7, 0, v2
    v_xor_b32 v7, v7, v3
    v_lshlrev_b32 v7, 4, v7
    v_lshl_add_u32 v8, v2, 9, v7
    v_add_u32 v7, 2, v2
    v_xor_b32 v7, v7, v3
    v_lshlrev_b32 v7, 4, v7
    v_lshl_add_u32 v9, v2, 9, v7
    v_add_u32 v7, 4, v2
    v_xor_b32 v7, v7, v3
    v_lshlrev_b32 v7, 4, v7
    v_lshl_add_u32 v10, v2, 9, v7
    v_add_u32 v7, 6, v2
    v_xor_b32 v7, v7, v3
    v_lshlrev_b32 v7, 4, v7
    v_lshl_add_u32 v11, v2, 9, v7
    v_add_u32 v7, 8, v2
    v_xor_b32 v7, v7, v3
    v_lshlrev_b32 v7, 4, v7
    v_lshl_add_u32 v12, v2, 9, v7
    v_add_u32 v7, 10, v2
    v_xor_b32 v7, v7, v3
    v_lshlrev_b32 v7, 4, v7
    v_lshl_add_u32 v13, v2, 9, v7
    v_add_u32 v7, 12, v2
    v_xor_b32 v7, v7, v3
    v_lshlrev_b32 v7, 4, v7
    v_lshl_add_u32 v14, v2, 9, v7
    v_add_u32 v7, 14, v2
    v_xor_b32 v7, v7, v3
    v_lshlrev_b32 v7, 4, v7
    v_lshl_add_u32 v15, v2, 9, v7
    v_and_b32 v7, 15, v1
    v_lshlrev_b32 v25, 9, v3
    s_lshl_b32 s43, s42, 14
    v_add_u32 v25, s43, v25
    v_add_u32 v26, 0, v2
    v_xor_b32 v26, v26, v7
    v_lshl_add_u32 v16, v26, 4, v25
    v_add_u32 v26, 2, v2
    v_xor_b32 v26, v26, v7
    v_lshl_add_u32 v17, v26, 4, v25
    v_add_u32 v26, 4, v2
    v_xor_b32 v26, v26, v7
    v_lshl_add_u32 v18, v26, 4, v25
    v_add_u32 v26, 6, v2
    v_xor_b32 v26, v26, v7
    v_lshl_add_u32 v19, v26, 4, v25
    v_add_u32 v26, 8, v2
    v_xor_b32 v26, v26, v7
    v_lshl_add_u32 v20, v26, 4, v25
    v_add_u32 v26, 10, v2
    v_xor_b32 v26, v26, v7
    v_lshl_add_u32 v21, v26, 4, v25
    v_add_u32 v26, 12, v2
    v_xor_b32 v26, v26, v7
    v_lshl_add_u32 v22, v26, 4, v25
    v_add_u32 v26, 14, v2
    v_xor_b32 v26, v26, v7
    v_lshl_add_u32 v23, v26, 4, v25
    v_lshrrev_b32 v24, 3, v1
    v_lshlrev_b32 v24, 8, v24
    v_and_b32 v26, 7, v1
    v_lshl_add_u32 v24, v26, 4, v24
    s_lshl_b32 s43, s41, 7
    v_add_u32 v24, s43, v24
    s_lshl_b32 s43, s42, 14
    s_lshl_b32 s44, s41, 13
    s_add_u32 s43, s43, s44
    v_lshlrev_b32 v5, 9, v2
    v_lshl_add_u32 v5, v3, 2, v5
    v_add_u32 v5, s43, v5
    v_lshlrev_b32 v7, 4, v1
    v_add_u32 v7, s43, v7
    s_waitcnt lgkmcnt(0)
    s_mov_b32 s8, s24
    s_and_b32 s9, s25, 0xffff
    s_mov_b32 s10, 5120000
    s_mov_b32 s11, 0x20000
    s_cmp_eq_u32 s38, 0
    s_cselect_b32 s12, s30, s28
    s_cselect_b32 s13, s31, s29
    s_cselect_b32 s16, s34, s32
    s_cselect_b32 s17, s35, s33
    s_cmp_lt_u32 s40, 4
    s_cselect_b32 s12, s12, s16
    s_cselect_b32 s13, s13, s17
    s_and_b32 s13, s13, 0xffff
    s_mov_b32 s14, 131072
    s_mov_b32 s15, 0x20000
    s_mul_i32 s43, s39, 2560256
    s_mul_i32 s44, s39, 2560000
    s_add_u32 s44, s44, 10241024
    s_cmp_eq_u32 s38, 0
    s_cselect_b32 s43, s43, s44
    s_add_u32 s20, s26, s43
    s_addc_u32 s21, s27, 0
    s_and_b32 s21, s21, 0xffff
    s_mov_b32 s22, 2560000
    s_mov_b32 s23, 0x20000
    s_lshl_b32 s45, s39, 7
    s_bfe_u32 s46, s40, 0x10001
    s_lshl_b32 s46, s46, 6
    s_add_u32 s45, s45, s46
    s_lshl_b32 s46, s41, 16
    s_add_u32 s45, s45, s46
    s_lshl_b32 s46, s42, 14
    s_lshl_b32 s47, s41, 13
    s_add_u32 s46, s46, s47
    s_add_u32 s46, s46, 65536
    s_mov_b32 m0, s46
    s_add_u32 s46, s46, 1024
    buffer_load_dwordx4 v4, s[12:15], s45 offen lds
    s_add_u32 s45, s45, 8192
    s_mov_b32 m0, s46
    s_add_u32 s46, s46, 1024
    buffer_load_dwordx4 v4, s[12:15], s45 offen lds
    s_add_u32 s45, s45, 8192
    s_mov_b32 m0, s46
    s_add_u32 s46, s46, 1024
    buffer_load_dwordx4 v4, s[12:15], s45 offen lds
    s_add_u32 s45, s45, 8192
    s_mov_b32 m0, s46
    s_add_u32 s46, s46, 1024
    buffer_load_dwordx4 v4, s[12:15], s45 offen lds
    s_add_u32 s45, s45, 8192
    s_mov_b32 m0, s46
    s_add_u32 s46, s46, 1024
    buffer_load_dwordx4 v4, s[12:15], s45 offen lds
    s_add_u32 s45, s45, 8192
    s_mov_b32 m0, s46
    s_add_u32 s46, s46, 1024
    buffer_load_dwordx4 v4, s[12:15], s45 offen lds
    s_add_u32 s45, s45, 8192
    s_mov_b32 m0, s46
    s_add_u32 s46, s46, 1024
    buffer_load_dwordx4 v4, s[12:15], s45 offen lds
    s_add_u32 s45, s45, 8192
    s_mov_b32 m0, s46
    s_add_u32 s46, s46, 1024
    buffer_load_dwordx4 v4, s[12:15], s45 offen lds
    s_add_u32 s45, s45, 8192
    s_lshl_b32 s47, s42, 14
    s_lshl_b32 s43, s41, 13
    s_add_u32 s47, s47, s43
    s_add_u32 s48, s36, s42
    s_lshl_b32 s48, s48, 14
    s_lshl_b32 s43, s41, 13
    s_add_u32 s48, s48, s43
    s_add_u32 s49, s47, 0
    s_mov_b32 m0, s49
    s_nop 0
    buffer_load_dwordx4 v8, s[8:11], s48 offen offset:0 lds
    buffer_load_dwordx4 v9, s[8:11], s48 offen offset:1024 lds
    buffer_load_dwordx4 v10, s[8:11], s48 offen offset:2048 lds
    buffer_load_dwordx4 v11, s[8:11], s48 offen offset:3072 lds
    s_add_u32 s49, s49, 4096
    s_add_u32 s48, s48, 4096
    s_mov_b32 m0, s49
    s_nop 0
    buffer_load_dwordx4 v12, s[8:11], s48 offen offset:0 lds
    buffer_load_dwordx4 v13, s[8:11], s48 offen offset:1024 lds
    buffer_load_dwordx4 v14, s[8:11], s48 offen offset:2048 lds
    buffer_load_dwordx4 v15, s[8:11], s48 offen offset:3072 lds
    s_or_b32 s43, s38, s4
    s_or_b32 s43, s43, s40
    s_cmp_lg_u32 s43, 0
    s_cbranch_scc1 K1_NODUMMY
    s_mov_b32 s52, s20
    s_mov_b32 s53, s21
    s_mov_b32 s54, 2560256
    s_mov_b32 s55, 0x20000
    v_lshlrev_b32 v26, 2, v1
    v_mov_b32 v27, 0x7180
    s_mov_b32 s43, 2560000
    buffer_store_dword v27, v26, s[52:55], s43 offen sc1
    s_waitcnt vmcnt(0)
K1_NODUMMY:
    s_mov_b32 s56, 0x00800000
    s_mov_b32 s57, 0x80000000
    s_mov_b32 s58, 0x7fff0000
    s_mov_b32 s60, 0
    s_mov_b32 s61, 0x10000
    s_cmp_lt_u32 s40, 4
    s_cbranch_scc1 K1_W0
    s_waitcnt vmcnt(8)
    s_branch K1_W1
K1_W0:
    s_waitcnt vmcnt(0)
K1_W1:
    s_barrier
    s_add_u32 s43, s36, 4
    s_lshl_b32 s43, s43, 14
    s_mul_i32 s44, s6, 20480
    s_add_u32 s43, s43, s44
    v_lshlrev_b32 v26, 7, v0
    s_movk_i32 s44, 160
    v_cmp_gt_u32 vcc, s44, v0
    s_and_saveexec_b64 s[52:53], vcc
    s_cbranch_execz K1_NOPF
    buffer_load_dword v30, v26, s[8:11], s43 offen
K1_NOPF:
    s_mov_b64 exec, s[52:53]
    s_cmp_lt_u32 s40, 4
    s_cbranch_scc1 K1_G0FIRST
    ds_read_b64_tr_b16 v[128:129], v6 offset:0
    ds_read_b64_tr_b16 v[130:131], v6 offset:256
    ds_read_b64_tr_b16 v[192:193], v6 offset:32768
    ds_read_b64_tr_b16 v[194:195], v6 offset:33024
    ds_read_b64_tr_b16 v[132:133], v6 offset:1024
    ds_read_b64_tr_b16 v[134:135], v6 offset:1280
    ds_read_b64_tr_b16 v[196:197], v6 offset:33792
    ds_read_b64_tr_b16 v[198:199], v6 offset:34048
    ds_read_b64_tr_b16 v[136:137], v6 offset:2048
    ds_read_b64_tr_b16 v[138:139], v6 offset:2304
    ds_read_b64_tr_b16 v[200:201], v6 offset:34816
    ds_read_b64_tr_b16 v[202:203], v6 offset:35072
    ds_read_b64_tr_b16 v[140:141], v6 offset:3072
    ds_read_b64_tr_b16 v[142:143], v6 offset:3328
    ds_read_b64_tr_b16 v[204:205], v6 offset:35840
    ds_read_b64_tr_b16 v[206:207], v6 offset:36096
    ds_read_b64_tr_b16 v[144:145], v6 offset:4096
    ds_read_b64_tr_b16 v[146:147], v6 offset:4352
    ds_read_b64_tr_b16 v[208:209], v6 offset:36864
    ds_read_b64_tr_b16 v[210:211], v6 offset:37120
    ds_read_b64_tr_b16 v[148:149], v6 offset:5120
    ds_read_b64_tr_b16 v[150:151], v6 offset:5376
    ds_read_b64_tr_b16 v[212:213], v6 offset:37888
    ds_read_b64_tr_b16 v[214:215], v6 offset:38144
    ds_read_b64_tr_b16 v[152:153], v6 offset:6144
    ds_read_b64_tr_b16 v[154:155], v6 offset:6400
    ds_read_b64_tr_b16 v[216:217], v6 offset:38912
    ds_read_b64_tr_b16 v[218:219], v6 offset:39168
    ds_read_b64_tr_b16 v[156:157], v6 offset:7168
    ds_read_b64_tr_b16 v[158:159], v6 offset:7424
    ds_read_b64_tr_b16 v[220:221], v6 offset:39936
    ds_read_b64_tr_b16 v[222:223], v6 offset:40192
    ds_read_b64_tr_b16 v[160:161], v6 offset:8192
    ds_read_b64_tr_b16 v[162:163], v6 offset:8448
    ds_read_b64_tr_b16 v[224:225], v6 offset:40960
    ds_read_b64_tr_b16 v[226:227], v6 offset:41216
    ds_read_b64_tr_b16 v[164:165], v6 offset:9216
    ds_read_b64_tr_b16 v[166:167], v6 offset:9472
    ds_read_b64_tr_b16 v[228:229], v6 offset:41984
    ds_read_b64_tr_b16 v[230:231], v6 offset:42240
    ds_read_b64_tr_b16 v[168:169], v6 offset:10240
    ds_read_b64_tr_b16 v[170:171], v6 offset:10496
    ds_read_b64_tr_b16 v[232:233], v6 offset:43008
    ds_read_b64_tr_b16 v[234:235], v6 offset:43264
    ds_read_b64_tr_b16 v[172:173], v6 offset:11264
    ds_read_b64_tr_b16 v[174:175], v6 offset:11520
    ds_read_b64_tr_b16 v[236:237], v6 offset:44032
    ds_read_b64_tr_b16 v[238:239], v6 offset:44288
    ds_read_b64_tr_b16 v[176:177], v6 offset:12288
    ds_read_b64_tr_b16 v[178:179], v6 offset:12544
    ds_read_b64_tr_b16 v[240:241], v6 offset:45056
    ds_read_b64_tr_b16 v[242:243], v6 offset:45312
    ds_read_b64_tr_b16 v[180:181], v6 offset:13312
    ds_read_b64_tr_b16 v[182:183], v6 offset:13568
    ds_read_b64_tr_b16 v[244:245], v6 offset:46080
    ds_read_b64_tr_b16 v[246:247], v6 offset:46336
    ds_read_b64_tr_b16 v[184:185], v6 offset:14336
    ds_read_b64_tr_b16 v[186:187], v6 offset:14592
    ds_read_b64_tr_b16 v[248:249], v6 offset:47104
    ds_read_b64_tr_b16 v[250:251], v6 offset:47360
    ds_read_b64_tr_b16 v[188:189], v6 offset:15360
    ds_read_b64_tr_b16 v[190:191], v6 offset:15616
    ds_read_b64_tr_b16 v[252:253], v6 offset:48128
    ds_read_b64_tr_b16 v[254:255], v6 offset:48384
    s_waitcnt lgkmcnt(0) vmcnt(0)
    s_barrier
    s_branch K1_LOOP
K1_G0FIRST:
    s_setprio 3
    ds_read_b128 v[32:35], v16 offset:0
    ds_read_b64_tr_b16 v[128:129], v6 offset:0
    ds_read_b64_tr_b16 v[130:131], v6 offset:256
    ds_read_b64_tr_b16 v[192:193], v6 offset:32768
    ds_read_b64_tr_b16 v[194:195], v6 offset:33024
    ds_read_b128 v[36:39], v17 offset:0
    ds_read_b64_tr_b16 v[132:133], v6 offset:1024
    ds_read_b64_tr_b16 v[134:135], v6 offset:1280
    ds_read_b64_tr_b16 v[196:197], v6 offset:33792
    ds_read_b64_tr_b16 v[198:199], v6 offset:34048
    ds_read_b128 v[40:43], v18 offset:0
    ds_read_b64_tr_b16 v[136:137], v6 offset:2048
    ds_read_b64_tr_b16 v[138:139], v6 offset:2304
    ds_read_b64_tr_b16 v[200:201], v6 offset:34816
    ds_read_b64_tr_b16 v[202:203], v6 offset:35072
    s_waitcnt lgkmcnt(10)
    v_mfma_f32_32x32x16_bf16 v[96:111], v[32:35], v[128:131], 0
    v_mfma_f32_32x32x16_bf16 v[112:127], v[32:35], v[192:195], 0
    ds_read_b128 v[44:47], v19 offset:0
    ds_read_b64_tr_b16 v[140:141], v6 offset:3072
    ds_read_b64_tr_b16 v[142:143], v6 offset:3328
    ds_read_b64_tr_b16 v[204:205], v6 offset:35840
    ds_read_b64_tr_b16 v[206:207], v6 offset:36096
    s_waitcnt lgkmcnt(10)
    v_mfma_f32_32x32x16_bf16 v[96:111], v[36:39], v[132:135], v[96:111]
    v_mfma_f32_32x32x16_bf16 v[112:127], v[36:39], v[196:199], v[112:127]
    ds_read_b128 v[48:51], v20 offset:0
    ds_read_b64_tr_b16 v[144:145], v6 offset:4096
    ds_read_b64_tr_b16 v[146:147], v6 offset:4352
    ds_read_b64_tr_b16 v[208:209], v6 offset:36864
    ds_read_b64_tr_b16 v[210:211], v6 offset:37120
    s_waitcnt lgkmcnt(10)
    v_mfma_f32_32x32x16_bf16 v[96:111], v[40:43], v[136:139], v[96:111]
    v_mfma_f32_32x32x16_bf16 v[112:127], v[40:43], v[200:203], v[112:127]
    ds_read_b128 v[52:55], v21 offset:0
    ds_read_b64_tr_b16 v[148:149], v6 offset:5120
    ds_read_b64_tr_b16 v[150:151], v6 offset:5376
    ds_read_b64_tr_b16 v[212:213], v6 offset:37888
    ds_read_b64_tr_b16 v[214:215], v6 offset:38144
    s_waitcnt lgkmcnt(10)
    v_mfma_f32_32x32x16_bf16 v[96:111], v[44:47], v[140:143], v[96:111]
    v_mfma_f32_32x32x16_bf16 v[112:127], v[44:47], v[204:207], v[112:127]
    ds_read_b128 v[56:59], v22 offset:0
    ds_read_b64_tr_b16 v[152:153], v6 offset:6144
    ds_read_b64_tr_b16 v[154:155], v6 offset:6400
    ds_read_b64_tr_b16 v[216:217], v6 offset:38912
    ds_read_b64_tr_b16 v[218:219], v6 offset:39168
    s_waitcnt lgkmcnt(10)
    v_mfma_f32_32x32x16_bf16 v[96:111], v[48:51], v[144:147], v[96:111]
    v_mfma_f32_32x32x16_bf16 v[112:127], v[48:51], v[208:211], v[112:127]
    ds_read_b128 v[60:63], v23 offset:0
    ds_read_b64_tr_b16 v[156:157], v6 offset:7168
    ds_read_b64_tr_b16 v[158:159], v6 offset:7424
    ds_read_b64_tr_b16 v[220:221], v6 offset:39936
    ds_read_b64_tr_b16 v[222:223], v6 offset:40192
    s_waitcnt lgkmcnt(10)
    v_mfma_f32_32x32x16_bf16 v[96:111], v[52:55], v[148:151], v[96:111]
    v_mfma_f32_32x32x16_bf16 v[112:127], v[52:55], v[212:215], v[112:127]
    ds_read_b128 v[64:67], v16 offset:256
    ds_read_b64_tr_b16 v[160:161], v6 offset:8192
    ds_read_b64_tr_b16 v[162:163], v6 offset:8448
    ds_read_b64_tr_b16 v[224:225], v6 offset:40960
    ds_read_b64_tr_b16 v[226:227], v6 offset:41216
    s_waitcnt lgkmcnt(10)
    v_mfma_f32_32x32x16_bf16 v[96:111], v[56:59], v[152:155], v[96:111]
    v_mfma_f32_32x32x16_bf16 v[112:127], v[56:59], v[216:219], v[112:127]
    ds_read_b128 v[68:71], v17 offset:256
    ds_read_b64_tr_b16 v[164:165], v6 offset:9216
    ds_read_b64_tr_b16 v[166:167], v6 offset:9472
    ds_read_b64_tr_b16 v[228:229], v6 offset:41984
    ds_read_b64_tr_b16 v[230:231], v6 offset:42240
    s_waitcnt lgkmcnt(10)
    v_mfma_f32_32x32x16_bf16 v[96:111], v[60:63], v[156:159], v[96:111]
    v_mfma_f32_32x32x16_bf16 v[112:127], v[60:63], v[220:223], v[112:127]
    ds_read_b128 v[72:75], v18 offset:256
    ds_read_b64_tr_b16 v[168:169], v6 offset:10240
    ds_read_b64_tr_b16 v[170:171], v6 offset:10496
    ds_read_b64_tr_b16 v[232:233], v6 offset:43008
    ds_read_b64_tr_b16 v[234:235], v6 offset:43264
    s_waitcnt lgkmcnt(10)
    v_mfma_f32_32x32x16_bf16 v[96:111], v[64:67], v[160:163], v[96:111]
    v_mfma_f32_32x32x16_bf16 v[112:127], v[64:67], v[224:227], v[112:127]
    ds_read_b128 v[76:79], v19 offset:256
    ds_read_b64_tr_b16 v[172:173], v6 offset:11264
    ds_read_b64_tr_b16 v[174:175], v6 offset:11520
    ds_read_b64_tr_b16 v[236:237], v6 offset:44032
    ds_read_b64_tr_b16 v[238:239], v6 offset:44288
    s_waitcnt lgkmcnt(10)
    v_mfma_f32_32x32x16_bf16 v[96:111], v[68:71], v[164:167], v[96:111]
    v_mfma_f32_32x32x16_bf16 v[112:127], v[68:71], v[228:231], v[112:127]
    ds_read_b128 v[80:83], v20 offset:256
    ds_read_b64_tr_b16 v[176:177], v6 offset:12288
    ds_read_b64_tr_b16 v[178:179], v6 offset:12544
    ds_read_b64_tr_b16 v[240:241], v6 offset:45056
    ds_read_b64_tr_b16 v[242:243], v6 offset:45312
    s_waitcnt lgkmcnt(10)
    v_mfma_f32_32x32x16_bf16 v[96:111], v[72:75], v[168:171], v[96:111]
    v_mfma_f32_32x32x16_bf16 v[112:127], v[72:75], v[232:235], v[112:127]
    ds_read_b128 v[84:87], v21 offset:256
    ds_read_b64_tr_b16 v[180:181], v6 offset:13312
    ds_read_b64_tr_b16 v[182:183], v6 offset:13568
    ds_read_b64_tr_b16 v[244:245], v6 offset:46080
    ds_read_b64_tr_b16 v[246:247], v6 offset:46336
    s_waitcnt lgkmcnt(10)
    v_mfma_f32_32x32x16_bf16 v[96:111], v[76:79], v[172:175], v[96:111]
    v_mfma_f32_32x32x16_bf16 v[112:127], v[76:79], v[236:239], v[112:127]
    ds_read_b128 v[88:91], v22 offset:256
    ds_read_b64_tr_b16 v[184:185], v6 offset:14336
    ds_read_b64_tr_b16 v[186:187], v6 offset:14592
    ds_read_b64_tr_b16 v[248:249], v6 offset:47104
    ds_read_b64_tr_b16 v[250:251], v6 offset:47360
    s_waitcnt lgkmcnt(10)
    v_mfma_f32_32x32x16_bf16 v[96:111], v[80:83], v[176:179], v[96:111]
    v_mfma_f32_32x32x16_bf16 v[112:127], v[80:83], v[240:243], v[112:127]
    ds_read_b128 v[92:95], v23 offset:256
    ds_read_b64_tr_b16 v[188:189], v6 offset:15360
    ds_read_b64_tr_b16 v[190:191], v6 offset:15616
    ds_read_b64_tr_b16 v[252:253], v6 offset:48128
    ds_read_b64_tr_b16 v[254:255], v6 offset:48384
    s_waitcnt lgkmcnt(10)
    v_mfma_f32_32x32x16_bf16 v[96:111], v[84:87], v[180:183], v[96:111]
    v_mfma_f32_32x32x16_bf16 v[112:127], v[84:87], v[244:247], v[112:127]
    s_waitcnt lgkmcnt(5)
    v_mfma_f32_32x32x16_bf16 v[96:111], v[88:91], v[184:187], v[96:111]
    v_mfma_f32_32x32x16_bf16 v[112:127], v[88:91], v[248:251], v[112:127]
    s_waitcnt lgkmcnt(0)
    v_mfma_f32_32x32x16_bf16 v[96:111], v[92:95], v[188:191], v[96:111]
    v_mfma_f32_32x32x16_bf16 v[112:127], v[92:95], v[252:255], v[112:127]
    s_mov_b32 s51, s42
    s_setprio 0
    s_barrier
    s_add_u32 s62, s51, 4
    s_add_u32 s48, s36, s62
    s_lshl_b32 s48, s48, 14
    s_lshl_b32 s43, s41, 13
    s_add_u32 s48, s48, s43
    s_add_u32 s49, s47, 65536
    s_mov_b32 m0, s49
    s_nop 0
    buffer_load_dwordx4 v8, s[8:11], s48 offen offset:0 lds
    buffer_load_dwordx4 v9, s[8:11], s48 offen offset:1024 lds
    buffer_load_dwordx4 v10, s[8:11], s48 offen offset:2048 lds
    buffer_load_dwordx4 v11, s[8:11], s48 offen offset:3072 lds
    s_add_u32 s49, s49, 4096
    s_add_u32 s48, s48, 4096
    s_mov_b32 m0, s49
    s_nop 0
    buffer_load_dwordx4 v12, s[8:11], s48 offen offset:0 lds
    buffer_load_dwordx4 v13, s[8:11], s48 offen offset:1024 lds
    buffer_load_dwordx4 v14, s[8:11], s48 offen offset:2048 lds
    buffer_load_dwordx4 v15, s[8:11], s48 offen offset:3072 lds
    s_branch K1_EPI
K1_LOOP:
    s_lshl_b32 s51, s60, 2
    s_add_u32 s51, s51, s42
    s_cmp_ge_u32 s51, s37
    s_cbranch_scc1 K1_NOMFMA
    s_setprio 3
    ds_read_b128 v[32:35], v16 offset:0
    ds_read_b128 v[36:39], v17 offset:0
    ds_read_b128 v[40:43], v18 offset:0
    ds_read_b128 v[44:47], v19 offset:0
    ds_read_b128 v[48:51], v20 offset:0
    ds_read_b128 v[52:55], v21 offset:0
    ds_read_b128 v[56:59], v22 offset:0
    ds_read_b128 v[60:63], v23 offset:0
    ds_read_b128 v[64:67], v16 offset:256
    ds_read_b128 v[68:71], v17 offset:256
    ds_read_b128 v[72:75], v18 offset:256
    ds_read_b128 v[76:79], v19 offset:256
    ds_read_b128 v[80:83], v20 offset:256
    ds_read_b128 v[84:87], v21 offset:256
    ds_read_b128 v[88:91], v22 offset:256
    ds_read_b128 v[92:95], v23 offset:256
    s_add_u32 s62, s51, 4
    s_cmp_ge_u32 s62, s37
    s_cbranch_scc1 K1_MF_NODMA
    s_add_u32 s48, s36, s62
    s_lshl_b32 s48, s48, 14
    s_lshl_b32 s43, s41, 13
    s_add_u32 s48, s48, s43
    s_add_u32 s49, s47, s61
    s_waitcnt lgkmcnt(15)
    v_mfma_f32_32x32x16_bf16 v[96:111], v[32:35], v[128:131], 0
    v_mfma_f32_32x32x16_bf16 v[112:127], v[32:35], v[192:195], 0
    s_waitcnt lgkmcnt(14)
    v_mfma_f32_32x32x16_bf16 v[96:111], v[36:39], v[132:135], v[96:111]
    v_mfma_f32_32x32x16_bf16 v[112:127], v[36:39], v[196:199], v[112:127]
    s_waitcnt lgkmcnt(13)
    s_mov_b32 m0, s49
    v_mfma_f32_32x32x16_bf16 v[96:111], v[40:43], v[136:139], v[96:111]
    v_mfma_f32_32x32x16_bf16 v[112:127], v[40:43], v[200:203], v[112:127]
    buffer_load_dwordx4 v8, s[8:11], s48 offen offset:0 lds
    s_waitcnt lgkmcnt(12)
    v_mfma_f32_32x32x16_bf16 v[96:111], v[44:47], v[140:143], v[96:111]
    v_mfma_f32_32x32x16_bf16 v[112:127], v[44:47], v[204:207], v[112:127]
    buffer_load_dwordx4 v9, s[8:11], s48 offen offset:1024 lds
    s_waitcnt lgkmcnt(11)
    v_mfma_f32_32x32x16_bf16 v[96:111], v[48:51], v[144:147], v[96:111]
    v_mfma_f32_32x32x16_bf16 v[112:127], v[48:51], v[208:211], v[112:127]
    buffer_load_dwordx4 v10, s[8:11], s48 offen offset:2048 lds
    s_waitcnt lgkmcnt(10)
    v_mfma_f32_32x32x16_bf16 v[96:111], v[52:55], v[148:151], v[96:111]
    v_mfma_f32_32x32x16_bf16 v[112:127], v[52:55], v[212:215], v[112:127]
    buffer_load_dwordx4 v11, s[8:11], s48 offen offset:3072 lds
    s_add_u32 s49, s49, 4096
    s_add_u32 s48, s48, 4096
    s_waitcnt lgkmcnt(9)
    s_mov_b32 m0, s49
    v_mfma_f32_32x32x16_bf16 v[96:111], v[56:59], v[152:155], v[96:111]
    v_mfma_f32_32x32x16_bf16 v[112:127], v[56:59], v[216:219], v[112:127]
    buffer_load_dwordx4 v12, s[8:11], s48 offen offset:0 lds
    s_waitcnt lgkmcnt(8)
    v_mfma_f32_32x32x16_bf16 v[96:111], v[60:63], v[156:159], v[96:111]
    v_mfma_f32_32x32x16_bf16 v[112:127], v[60:63], v[220:223], v[112:127]
    buffer_load_dwordx4 v13, s[8:11], s48 offen offset:1024 lds
    s_waitcnt lgkmcnt(7)
    v_mfma_f32_32x32x16_bf16 v[96:111], v[64:67], v[160:163], v[96:111]
    v_mfma_f32_32x32x16_bf16 v[112:127], v[64:67], v[224:227], v[112:127]
    buffer_load_dwordx4 v14, s[8:11], s48 offen offset:2048 lds
    s_waitcnt lgkmcnt(6)
    v_mfma_f32_32x32x16_bf16 v[96:111], v[68:71], v[164:167], v[96:111]
    v_mfma_f32_32x32x16_bf16 v[112:127], v[68:71], v[228:231], v[112:127]
    buffer_load_dwordx4 v15, s[8:11], s48 offen offset:3072 lds
    s_waitcnt lgkmcnt(5)
    v_mfma_f32_32x32x16_bf16 v[96:111], v[72:75], v[168:171], v[96:111]
    v_mfma_f32_32x32x16_bf16 v[112:127], v[72:75], v[232:235], v[112:127]
    s_waitcnt lgkmcnt(4)
    v_mfma_f32_32x32x16_bf16 v[96:111], v[76:79], v[172:175], v[96:111]
    v_mfma_f32_32x32x16_bf16 v[112:127], v[76:79], v[236:239], v[112:127]
    s_waitcnt lgkmcnt(3)
    v_mfma_f32_32x32x16_bf16 v[96:111], v[80:83], v[176:179], v[96:111]
    v_mfma_f32_32x32x16_bf16 v[112:127], v[80:83], v[240:243], v[112:127]
    s_waitcnt lgkmcnt(2)
    v_mfma_f32_32x32x16_bf16 v[96:111], v[84:87], v[180:183], v[96:111]
    v_mfma_f32_32x32x16_bf16 v[112:127], v[84:87], v[244:247], v[112:127]
    s_waitcnt lgkmcnt(1)
    v_mfma_f32_32x32x16_bf16 v[96:111], v[88:91], v[184:187], v[96:111]
    v_mfma_f32_32x32x16_bf16 v[112:127], v[88:91], v[248:251], v[112:127]
    s_waitcnt lgkmcnt(0)
    v_mfma_f32_32x32x16_bf16 v[96:111], v[92:95], v[188:191], v[96:111]
    v_mfma_f32_32x32x16_bf16 v[112:127], v[92:95], v[252:255], v[112:127]
    s_branch K1_MF_DONE
K1_MF_NODMA:
    s_waitcnt lgkmcnt(15)
    v_mfma_f32_32x32x16_bf16 v[96:111], v[32:35], v[128:131], 0
    v_mfma_f32_32x32x16_bf16 v[112:127], v[32:35], v[192:195], 0
    s_waitcnt lgkmcnt(14)
    v_mfma_f32_32x32x16_bf16 v[96:111], v[36:39], v[132:135], v[96:111]
    v_mfma_f32_32x32x16_bf16 v[112:127], v[36:39], v[196:199], v[112:127]
    s_waitcnt lgkmcnt(13)
    v_mfma_f32_32x32x16_bf16 v[96:111], v[40:43], v[136:139], v[96:111]
    v_mfma_f32_32x32x16_bf16 v[112:127], v[40:43], v[200:203], v[112:127]
    s_waitcnt lgkmcnt(12)
    v_mfma_f32_32x32x16_bf16 v[96:111], v[44:47], v[140:143], v[96:111]
    v_mfma_f32_32x32x16_bf16 v[112:127], v[44:47], v[204:207], v[112:127]
    s_waitcnt lgkmcnt(11)
    v_mfma_f32_32x32x16_bf16 v[96:111], v[48:51], v[144:147], v[96:111]
    v_mfma_f32_32x32x16_bf16 v[112:127], v[48:51], v[208:211], v[112:127]
    s_waitcnt lgkmcnt(10)
    v_mfma_f32_32x32x16_bf16 v[96:111], v[52:55], v[148:151], v[96:111]
    v_mfma_f32_32x32x16_bf16 v[112:127], v[52:55], v[212:215], v[112:127]
    s_waitcnt lgkmcnt(9)
    v_mfma_f32_32x32x16_bf16 v[96:111], v[56:59], v[152:155], v[96:111]
    v_mfma_f32_32x32x16_bf16 v[112:127], v[56:59], v[216:219], v[112:127]
    s_waitcnt lgkmcnt(8)
    v_mfma_f32_32x32x16_bf16 v[96:111], v[60:63], v[156:159], v[96:111]
    v_mfma_f32_32x32x16_bf16 v[112:127], v[60:63], v[220:223], v[112:127]
    s_waitcnt lgkmcnt(7)
    v_mfma_f32_32x32x16_bf16 v[96:111], v[64:67], v[160:163], v[96:111]
    v_mfma_f32_32x32x16_bf16 v[112:127], v[64:67], v[224:227], v[112:127]
    s_waitcnt lgkmcnt(6)
    v_mfma_f32_32x32x16_bf16 v[96:111], v[68:71], v[164:167], v[96:111]
    v_mfma_f32_32x32x16_bf16 v[112:127], v[68:71], v[228:231], v[112:127]
    s_waitcnt lgkmcnt(5)
    v_mfma_f32_32x32x16_bf16 v[96:111], v[72:75], v[168:171], v[96:111]
    v_mfma_f32_32x32x16_bf16 v[112:127], v[72:75], v[232:235], v[112:127]
    s_waitcnt lgkmcnt(4)
    v_mfma_f32_32x32x16_bf16 v[96:111], v[76:79], v[172:175], v[96:111]
    v_mfma_f32_32x32x16_bf16 v[112:127], v[76:79], v[236:239], v[112:127]
    s_waitcnt lgkmcnt(3)
    v_mfma_f32_32x32x16_bf16 v[96:111], v[80:83], v[176:179], v[96:111]
    v_mfma_f32_32x32x16_bf16 v[112:127], v[80:83], v[240:243], v[112:127]
    s_waitcnt lgkmcnt(2)
    v_mfma_f32_32x32x16_bf16 v[96:111], v[84:87], v[180:183], v[96:111]
    v_mfma_f32_32x32x16_bf16 v[112:127], v[84:87], v[244:247], v[112:127]
    s_waitcnt lgkmcnt(1)
    v_mfma_f32_32x32x16_bf16 v[96:111], v[88:91], v[184:187], v[96:111]
    v_mfma_f32_32x32x16_bf16 v[112:127], v[88:91], v[248:251], v[112:127]
    s_waitcnt lgkmcnt(0)
    v_mfma_f32_32x32x16_bf16 v[96:111], v[92:95], v[188:191], v[96:111]
    v_mfma_f32_32x32x16_bf16 v[112:127], v[92:95], v[252:255], v[112:127]
K1_MF_DONE:
    s_setprio 0
K1_NOMFMA:
    s_barrier
K1_EPI:
    s_cmp_ge_u32 s51, s37
    s_cbranch_scc1 K1_NOEPI
    s_add_u32 s50, s36, s51
    s_lshl_b32 s59, s50, 13
    s_nop 7
    s_cmp_eq_u32 s38, 0
    s_cbranch_scc0 K1_EPIAU
    v_mul_f32 v48, 0xbfb8aa3b, v96
    v_mul_f32 v49, 0xbfb8aa3b, v97
    v_mul_f32 v50, 0xbfb8aa3b, v98
    v_mul_f32 v51, 0xbfb8aa3b, v99
    v_max_f32_e64 v56, |v112|, s56
    v_max_f32_e64 v57, |v113|, s56
    v_max_f32_e64 v58, |v114|, s56
    v_max_f32_e64 v59, |v115|, s56
    v_cvt_pk_bf16_f32 v52, v48, 0
    v_cvt_pk_bf16_f32 v53, v49, 0
    v_cvt_pk_bf16_f32 v54, v50, 0
    v_cvt_pk_bf16_f32 v55, v51, 0
    v_add_u32 v56, 0x8000, v56
    v_add_u32 v57, 0x8000, v57
    v_add_u32 v58, 0x8000, v58
    v_add_u32 v59, 0x8000, v59
    v_sub_u32 v48, v56, v52
    v_sub_u32 v49, v57, v53
    v_sub_u32 v50, v58, v54
    v_sub_u32 v51, v59, v55
    v_bfi_b32 v52, s57, v112, v52
    v_bfi_b32 v53, s57, v113, v53
    v_bfi_b32 v54, s57, v114, v54
    v_bfi_b32 v55, s57, v115, v55
    v_bfi_b32 v96, s58, v48, v52
    v_bfi_b32 v97, s58, v49, v53
    v_bfi_b32 v98, s58, v50, v54
    v_bfi_b32 v99, s58, v51, v55
    ds_write_b32 v5, v96 offset:0
    ds_write_b32 v5, v97 offset:128
    ds_write_b32 v5, v98 offset:256
    ds_write_b32 v5, v99 offset:384
    v_mul_f32 v64, 0xbfb8aa3b, v100
    v_mul_f32 v65, 0xbfb8aa3b, v101
    v_mul_f32 v66, 0xbfb8aa3b, v102
    v_mul_f32 v67, 0xbfb8aa3b, v103
    v_max_f32_e64 v72, |v116|, s56
    v_max_f32_e64 v73, |v117|, s56
    v_max_f32_e64 v74, |v118|, s56
    v_max_f32_e64 v75, |v119|, s56
    v_cvt_pk_bf16_f32 v68, v64, 0
    v_cvt_pk_bf16_f32 v69, v65, 0
    v_cvt_pk_bf16_f32 v70, v66, 0
    v_cvt_pk_bf16_f32 v71, v67, 0
    v_add_u32 v72, 0x8000, v72
    v_add_u32 v73, 0x8000, v73
    v_add_u32 v74, 0x8000, v74
    v_add_u32 v75, 0x8000, v75
    v_sub_u32 v64, v72, v68
    v_sub_u32 v65, v73, v69
    v_sub_u32 v66, v74, v70
    v_sub_u32 v67, v75, v71
    v_bfi_b32 v68, s57, v116, v68
    v_bfi_b32 v69, s57, v117, v69
    v_bfi_b32 v70, s57, v118, v70
    v_bfi_b32 v71, s57, v119, v71
    v_bfi_b32 v100, s58, v64, v68
    v_bfi_b32 v101, s58, v65, v69
    v_bfi_b32 v102, s58, v66, v70
    v_bfi_b32 v103, s58, v67, v71
    ds_write_b32 v5, v100 offset:1024
    ds_write_b32 v5, v101 offset:1152
    ds_write_b32 v5, v102 offset:1280
    ds_write_b32 v5, v103 offset:1408
    v_mul_f32 v48, 0xbfb8aa3b, v104
    v_mul_f32 v49, 0xbfb8aa3b, v105
    v_mul_f32 v50, 0xbfb8aa3b, v106
    v_mul_f32 v51, 0xbfb8aa3b, v107
    v_max_f32_e64 v56, |v120|, s56
    v_max_f32_e64 v57, |v121|, s56
    v_max_f32_e64 v58, |v122|, s56
    v_max_f32_e64 v59, |v123|, s56
    v_cvt_pk_bf16_f32 v52, v48, 0
    v_cvt_pk_bf16_f32 v53, v49, 0
    v_cvt_pk_bf16_f32 v54, v50, 0
    v_cvt_pk_bf16_f32 v55, v51, 0
    v_add_u32 v56, 0x8000, v56
    v_add_u32 v57, 0x8000, v57
    v_add_u32 v58, 0x8000, v58
    v_add_u32 v59, 0x8000, v59
    v_sub_u32 v48, v56, v52
    v_sub_u32 v49, v57, v53
    v_sub_u32 v50, v58, v54
    v_sub_u32 v51, v59, v55
    v_bfi_b32 v52, s57, v120, v52
    v_bfi_b32 v53, s57, v121, v53
    v_bfi_b32 v54, s57, v122, v54
    v_bfi_b32 v55, s57, v123, v55
    v_bfi_b32 v104, s58, v48, v52
    v_bfi_b32 v105, s58, v49, v53
    v_bfi_b32 v106, s58, v50, v54
    v_bfi_b32 v107, s58, v51, v55
    ds_write_b32 v5, v104 offset:2048
    ds_write_b32 v5, v105 offset:2176
    ds_write_b32 v5, v106 offset:2304
    ds_write_b32 v5, v107 offset:2432
    v_mul_f32 v64, 0xbfb8aa3b, v108
    v_mul_f32 v65, 0xbfb8aa3b, v109
    v_mul_f32 v66, 0xbfb8aa3b, v110
    v_mul_f32 v67, 0xbfb8aa3b, v111
    v_max_f32_e64 v72, |v124|, s56
    v_max_f32_e64 v73, |v125|, s56
    v_max_f32_e64 v74, |v126|, s56
    v_max_f32_e64 v75, |v127|, s56
    v_cvt_pk_bf16_f32 v68, v64, 0
    v_cvt_pk_bf16_f32 v69, v65, 0
    v_cvt_pk_bf16_f32 v70, v66, 0
    v_cvt_pk_bf16_f32 v71, v67, 0
    v_add_u32 v72, 0x8000, v72
    v_add_u32 v73, 0x8000, v73
    v_add_u32 v74, 0x8000, v74
    v_add_u32 v75, 0x8000, v75
    v_sub_u32 v64, v72, v68
    v_sub_u32 v65, v73, v69
    v_sub_u32 v66, v74, v70
    v_sub_u32 v67, v75, v71
    v_bfi_b32 v68, s57, v124, v68
    v_bfi_b32 v69, s57, v125, v69
    v_bfi_b32 v70, s57, v126, v70
    v_bfi_b32 v71, s57, v127, v71
    v_bfi_b32 v108, s58, v64, v68
    v_bfi_b32 v109, s58, v65, v69
    v_bfi_b32 v110, s58, v66, v70
    v_bfi_b32 v111, s58, v67, v71
    ds_write_b32 v5, v108 offset:3072
    ds_write_b32 v5, v109 offset:3200
    ds_write_b32 v5, v110 offset:3328
    ds_write_b32 v5, v111 offset:3456
    s_branch K1_EPIJ
K1_EPIAU:
    v_mul_f32 v48, 0xbfb8aa3b, v96
    v_mul_f32 v49, 0xbfb8aa3b, v97
    v_mul_f32 v50, 0xbfb8aa3b, v98
    v_mul_f32 v51, 0xbfb8aa3b, v99
    v_cvt_pk_bf16_f32 v96, v48, v112
    v_cvt_pk_bf16_f32 v97, v49, v113
    v_cvt_pk_bf16_f32 v98, v50, v114
    v_cvt_pk_bf16_f32 v99, v51, v115
    ds_write_b32 v5, v96 offset:0
    ds_write_b32 v5, v97 offset:128
    ds_write_b32 v5, v98 offset:256
    ds_write_b32 v5, v99 offset:384
    v_mul_f32 v64, 0xbfb8aa3b, v100
    v_mul_f32 v65, 0xbfb8aa3b, v101
    v_mul_f32 v66, 0xbfb8aa3b, v102
    v_mul_f32 v67, 0xbfb8aa3b, v103
    v_cvt_pk_bf16_f32 v100, v64, v116
    v_cvt_pk_bf16_f32 v101, v65, v117
    v_cvt_pk_bf16_f32 v102, v66, v118
    v_cvt_pk_bf16_f32 v103, v67, v119
    ds_write_b32 v5, v100 offset:1024
    ds_write_b32 v5, v101 offset:1152
    ds_write_b32 v5, v102 offset:1280
    ds_write_b32 v5, v103 offset:1408
    v_mul_f32 v48, 0xbfb8aa3b, v104
    v_mul_f32 v49, 0xbfb8aa3b, v105
    v_mul_f32 v50, 0xbfb8aa3b, v106
    v_mul_f32 v51, 0xbfb8aa3b, v107
    v_cvt_pk_bf16_f32 v104, v48, v120
    v_cvt_pk_bf16_f32 v105, v49, v121
    v_cvt_pk_bf16_f32 v106, v50, v122
    v_cvt_pk_bf16_f32 v107, v51, v123
    ds_write_b32 v5, v104 offset:2048
    ds_write_b32 v5, v105 offset:2176
    ds_write_b32 v5, v106 offset:2304
    ds_write_b32 v5, v107 offset:2432
    v_mul_f32 v64, 0xbfb8aa3b, v108
    v_mul_f32 v65, 0xbfb8aa3b, v109
    v_mul_f32 v66, 0xbfb8aa3b, v110
    v_mul_f32 v67, 0xbfb8aa3b, v111
    v_cvt_pk_bf16_f32 v108, v64, v124
    v_cvt_pk_bf16_f32 v109, v65, v125
    v_cvt_pk_bf16_f32 v110, v66, v126
    v_cvt_pk_bf16_f32 v111, v67, v127
    ds_write_b32 v5, v108 offset:3072
    ds_write_b32 v5, v109 offset:3200
    ds_write_b32 v5, v110 offset:3328
    ds_write_b32 v5, v111 offset:3456
K1_EPIJ:
    s_waitcnt lgkmcnt(0)
    ds_read_b128 v[32:35], v7 offset:0
    ds_read_b128 v[36:39], v7 offset:1024
    ds_read_b128 v[40:43], v7 offset:2048
    ds_read_b128 v[44:47], v7 offset:3072
    s_waitcnt lgkmcnt(3)
    buffer_store_dwordx4 v[32:35], v24, s[20:23], s59 offen sc1
    s_add_u32 s59, s59, 2048
    s_waitcnt lgkmcnt(2)
    buffer_store_dwordx4 v[36:39], v24, s[20:23], s59 offen sc1
    s_add_u32 s59, s59, 2048
    s_waitcnt lgkmcnt(1)
    buffer_store_dwordx4 v[40:43], v24, s[20:23], s59 offen sc1
    s_add_u32 s59, s59, 2048
    s_waitcnt lgkmcnt(0)
    buffer_store_dwordx4 v[44:47], v24, s[20:23], s59 offen sc1
    s_waitcnt vmcnt(4)
    s_branch K1_EPID
K1_NOEPI:
    s_waitcnt vmcnt(0)
K1_EPID:
    v_xor_b32 v16, 0x10000, v16
    v_xor_b32 v17, 0x10000, v17
    v_xor_b32 v18, 0x10000, v18
    v_xor_b32 v19, 0x10000, v19
    v_xor_b32 v20, 0x10000, v20
    v_xor_b32 v21, 0x10000, v21
    v_xor_b32 v22, 0x10000, v22
    v_xor_b32 v23, 0x10000, v23
    v_xor_b32 v5, 0x10000, v5
    v_xor_b32 v7, 0x10000, v7
    s_xor_b32 s61, s61, 0x10000
    s_add_u32 s60, s60, 1
    s_cmp_lt_u32 s60, 4
    s_cbranch_scc0 K1_LOOPD
    s_barrier
    s_branch K1_LOOP
K1_LOOPD:
    s_cmp_ge_u32 s40, 4
    s_cbranch_scc1 K1_GEND
    s_barrier
K1_GEND:
    s_branch K1_END
K1_SORT:
    s_load_dwordx2 s[24:25], s[0:1], 8
    s_load_dwordx4 s[28:31], s[0:1], 16
    s_load_dwordx2 s[26:27], s[0:1], 88
    v_and_b32 v1, 63, v0
    v_lshlrev_b32 v2, 2, v0
    v_lshlrev_b32 v3, 5, v0
    v_mov_b32 v4, 0
    v_cmp_gt_u32 vcc, 64, v0
    s_and_saveexec_b64 s[40:41], vcc
    ds_write_b32 v2, v4 offset:0
    s_mov_b64 exec, s[40:41]
    s_mul_i32 s3, s2, 10000
    s_mul_i32 s4, s2, 80000
    s_waitcnt lgkmcnt(0)
    s_add_u32 s8, s24, s4
    s_addc_u32 s9, s25, 0
    s_and_b32 s9, s9, 0xffff
    s_mov_b32 s10, 80000
    s_mov_b32 s11, 0x20000
    s_add_u32 s12, s28, s3
    s_addc_u32 s13, s29, 0
    s_and_b32 s13, s13, 0xffff
    s_mov_b32 s14, 10000
    s_mov_b32 s15, 0x20000
    s_add_u32 s16, s30, s3
    s_addc_u32 s17, s31, 0
    s_and_b32 s17, s17, 0xffff
    s_mov_b32 s18, 10000
    s_mov_b32 s19, 0x20000
    s_add_u32 s5, s4, 21121024
    s_add_u32 s20, s26, s5
    s_addc_u32 s21, s27, 0
    s_and_b32 s21, s21, 0xffff
    s_mov_b32 s22, 80000
    s_mov_b32 s23, 0x20000
    s_add_u32 s5, s3, 20481024
    s_add_u32 s32, s26, s5
    s_addc_u32 s33, s27, 0
    s_and_b32 s33, s33, 0xffff
    s_mov_b32 s34, 10000
    s_mov_b32 s35, 0x20000
    s_add_u32 s36, s26, 26241024
    s_addc_u32 s37, s27, 0
    s_and_b32 s37, s37, 0xffff
    s_mov_b32 s38, 16384
    s_mov_b32 s39, 0x20000
    s_mov_b32 s6, 0
    buffer_load_dword v8, v2, s[16:19], s6 offen
    s_mov_b32 s6, 2048
    buffer_load_dword v9, v2, s[16:19], s6 offen
    s_mov_b32 s6, 4096
    buffer_load_dword v10, v2, s[16:19], s6 offen
    s_mov_b32 s6, 6144
    buffer_load_dword v11, v2, s[16:19], s6 offen
    s_mov_b32 s6, 8192
    buffer_load_dword v12, v2, s[16:19], s6 offen
    s_mov_b32 s6, 0
    buffer_load_dword v13, v2, s[12:15], s6 offen
    s_mov_b32 s6, 2048
    buffer_load_dword v14, v2, s[12:15], s6 offen
    s_mov_b32 s6, 4096
    buffer_load_dword v15, v2, s[12:15], s6 offen
    s_mov_b32 s6, 6144
    buffer_load_dword v16, v2, s[12:15], s6 offen
    s_mov_b32 s6, 8192
    buffer_load_dword v17, v2, s[12:15], s6 offen
    s_barrier
    s_waitcnt vmcnt(0)
    s_mov_b32 s6, 0
    buffer_load_dwordx4 v[32:35], v3, s[8:11], s6 offen
    buffer_load_dwordx4 v[36:39], v3, s[8:11], s6 offen offset:16
    s_mov_b32 s6, 16384
    buffer_load_dwordx4 v[40:43], v3, s[8:11], s6 offen
    buffer_load_dwordx4 v[44:47], v3, s[8:11], s6 offen offset:16
    s_mov_b32 s6, 32768
    buffer_load_dwordx4 v[48:51], v3, s[8:11], s6 offen
    buffer_load_dwordx4 v[52:55], v3, s[8:11], s6 offen offset:16
    s_mov_b32 s6, 49152
    buffer_load_dwordx4 v[56:59], v3, s[8:11], s6 offen
    buffer_load_dwordx4 v[60:63], v3, s[8:11], s6 offen offset:16
    s_mov_b32 s6, 65536
    buffer_load_dwordx4 v[64:67], v3, s[8:11], s6 offen
    buffer_load_dwordx4 v[68:71], v3, s[8:11], s6 offen offset:16
    s_mov_b32 s6, 26716
    v_mov_b32 v4, 1
    s_movk_i32 s7, 452
    v_cmp_gt_u32 s[42:43], s7, v0
    v_mul_u32_u24 v18, s6, v8
    v_lshrrev_b32 v18, 22, v18
    v_mul_u32_u24 v5, 157, v18
    v_sub_u32 v5, v8, v5
    v_lshl_or_b32 v13, v13, 8, v5
    v_lshlrev_b32 v18, 2, v18
    ds_add_rtn_u32 v23, v18, v4 offset:0
    v_mul_u32_u24 v19, s6, v9
    v_lshrrev_b32 v19, 22, v19
    v_mul_u32_u24 v5, 157, v19
    v_sub_u32 v5, v9, v5
    v_lshl_or_b32 v14, v14, 8, v5
    v_lshlrev_b32 v19, 2, v19
    ds_add_rtn_u32 v24, v19, v4 offset:0
    v_mul_u32_u24 v20, s6, v10
    v_lshrrev_b32 v20, 22, v20
    v_mul_u32_u24 v5, 157, v20
    v_sub_u32 v5, v10, v5
    v_lshl_or_b32 v15, v15, 8, v5
    v_lshlrev_b32 v20, 2, v20
    ds_add_rtn_u32 v25, v20, v4 offset:0
    v_mul_u32_u24 v21, s6, v11
    v_lshrrev_b32 v21, 22, v21
    v_mul_u32_u24 v5, 157, v21
    v_sub_u32 v5, v11, v5
    v_lshl_or_b32 v16, v16, 8, v5
    v_lshlrev_b32 v21, 2, v21
    ds_add_rtn_u32 v26, v21, v4 offset:0
    v_mul_u32_u24 v22, s6, v12
    v_lshrrev_b32 v22, 22, v22
    v_mul_u32_u24 v5, 157, v22
    v_sub_u32 v5, v12, v5
    v_lshl_or_b32 v17, v17, 8, v5
    v_lshlrev_b32 v22, 2, v22
    s_mov_b64 exec, s[42:43]
    ds_add_rtn_u32 v27, v22, v4 offset:0
    s_mov_b64 exec, -1
    s_waitcnt lgkmcnt(0)
    s_barrier
    v_lshlrev_b32 v5, 2, v1
    ds_read_b32 v6, v5 offset:0
    s_waitcnt lgkmcnt(0)
    v_mov_b32 v7, v6
    s_nop 1
    v_add_u32_dpp v7, v7, v7 row_shr:1 row_mask:0xf bank_mask:0xf bound_ctrl:0
    s_nop 1
    v_add_u32_dpp v7, v7, v7 row_shr:2 row_mask:0xf bank_mask:0xf bound_ctrl:0
    s_nop 1
    v_add_u32_dpp v7, v7, v7 row_shr:4 row_mask:0xf bank_mask:0xf bound_ctrl:0
    s_nop 1
    v_add_u32_dpp v7, v7, v7 row_shr:8 row_mask:0xf bank_mask:0xf bound_ctrl:0
    s_nop 1
    v_add_u32_dpp v7, v7, v7 row_bcast:15 row_mask:0xa bank_mask:0xf
    s_nop 1
    v_add_u32_dpp v7, v7, v7 row_bcast:31 row_mask:0xc bank_mask:0xf
    s_nop 1
    v_sub_u32 v7, v7, v6
    v_cmp_gt_u32 vcc, 64, v0
    s_and_saveexec_b64 s[40:41], vcc
    s_cbranch_execz K1_NOOFF
    v_lshl_or_b32 v28, v6, 16, v7
    v_lshlrev_b32 v29, 8, v1
    s_lshl_b32 s6, s2, 2
    buffer_store_dword v28, v29, s[36:39], s6 offen
K1_NOOFF:
    s_mov_b64 exec, s[40:41]
    ds_bpermute_b32 v8, v18, v7
    ds_bpermute_b32 v9, v19, v7
    ds_bpermute_b32 v10, v20, v7
    ds_bpermute_b32 v11, v21, v7
    ds_bpermute_b32 v12, v22, v7
    s_waitcnt lgkmcnt(0)
    s_waitcnt vmcnt(0)
    v_add_u32 v8, v8, v23
    v_lshlrev_b32 v18, 2, v8
    v_lshlrev_b32 v23, 5, v8
    ds_write_b32 v18, v13 offset:256
    ds_write_b128 v23, v[32:35] offset:10496
    ds_write_b128 v23, v[36:39] offset:10512
    v_add_u32 v9, v9, v24
    v_lshlrev_b32 v19, 2, v9
    v_lshlrev_b32 v24, 5, v9
    ds_write_b32 v19, v14 offset:256
    ds_write_b128 v24, v[40:43] offset:10496
    ds_write_b128 v24, v[44:47] offset:10512
    v_add_u32 v10, v10, v25
    v_lshlrev_b32 v20, 2, v10
    v_lshlrev_b32 v25, 5, v10
    ds_write_b32 v20, v15 offset:256
    ds_write_b128 v25, v[48:51] offset:10496
    ds_write_b128 v25, v[52:55] offset:10512
    v_add_u32 v11, v11, v26
    v_lshlrev_b32 v21, 2, v11
    v_lshlrev_b32 v26, 5, v11
    ds_write_b32 v21, v16 offset:256
    ds_write_b128 v26, v[56:59] offset:10496
    ds_write_b128 v26, v[60:63] offset:10512
    v_add_u32 v12, v12, v27
    v_lshlrev_b32 v22, 2, v12
    v_lshlrev_b32 v27, 5, v12
    s_mov_b64 exec, s[42:43]
    ds_write_b32 v22, v17 offset:256
    ds_write_b128 v27, v[64:67] offset:10496
    ds_write_b128 v27, v[68:71] offset:10512
    s_mov_b64 exec, -1
    s_waitcnt lgkmcnt(0)
    s_barrier
    v_lshlrev_b32 v5, 4, v0
    v_add_u32 v6, 57344, v5
    ds_read_b128 v[32:35], v5 offset:10496
    ds_read_b128 v[36:39], v5 offset:18688
    ds_read_b128 v[40:43], v5 offset:26880
    ds_read_b128 v[44:47], v5 offset:35072
    ds_read_b128 v[48:51], v5 offset:43264
    ds_read_b128 v[52:55], v5 offset:51456
    ds_read_b128 v[56:59], v5 offset:59648
    ds_read_b128 v[60:63], v6 offset:10496
    ds_read_b128 v[64:67], v6 offset:18688
    ds_read_b128 v[68:71], v6 offset:26880
    ds_read_b128 v[72:75], v5 offset:256
    ds_read_b128 v[76:79], v5 offset:8448
    s_waitcnt lgkmcnt(11)
    s_mov_b32 s6, 0
    buffer_store_dwordx4 v[32:35], v5, s[20:23], s6 offen sc1
    s_waitcnt lgkmcnt(10)
    s_mov_b32 s6, 8192
    buffer_store_dwordx4 v[36:39], v5, s[20:23], s6 offen sc1
    s_waitcnt lgkmcnt(9)
    s_mov_b32 s6, 16384
    buffer_store_dwordx4 v[40:43], v5, s[20:23], s6 offen sc1
    s_waitcnt lgkmcnt(8)
    s_mov_b32 s6, 24576
    buffer_store_dwordx4 v[44:47], v5, s[20:23], s6 offen sc1
    s_waitcnt lgkmcnt(7)
    s_mov_b32 s6, 32768
    buffer_store_dwordx4 v[48:51], v5, s[20:23], s6 offen sc1
    s_waitcnt lgkmcnt(6)
    s_mov_b32 s6, 40960
    buffer_store_dwordx4 v[52:55], v5, s[20:23], s6 offen sc1
    s_waitcnt lgkmcnt(5)
    s_mov_b32 s6, 49152
    buffer_store_dwordx4 v[56:59], v5, s[20:23], s6 offen sc1
    s_waitcnt lgkmcnt(4)
    s_mov_b32 s6, 57344
    buffer_store_dwordx4 v[60:63], v5, s[20:23], s6 offen sc1
    s_waitcnt lgkmcnt(3)
    s_mov_b32 s6, 65536
    buffer_store_dwordx4 v[64:67], v5, s[20:23], s6 offen sc1
    s_waitcnt lgkmcnt(2)
    s_mov_b32 s6, 73728
    buffer_store_dwordx4 v[68:71], v5, s[20:23], s6 offen sc1
    s_waitcnt lgkmcnt(1)
    s_mov_b32 s6, 0
    buffer_store_dwordx4 v[72:75], v5, s[32:35], s6 offen sc1
    s_waitcnt lgkmcnt(0)
    s_mov_b32 s6, 8192
    buffer_store_dwordx4 v[76:79], v5, s[32:35], s6 offen sc1
K1_END:
    s_endpgm
.globl standalone__edge_featured_mpnn_gatedgcn__graph_kernel
.p2align 8
.type standalone__edge_featured_mpnn_gatedgcn__graph_kernel,@function
standalone__edge_featured_mpnn_gatedgcn__graph_kernel:
    s_cmp_ge_u32 s2, 256
    s_cbranch_scc1 K2_END2
    s_load_dwordx2 s[8:9], s[0:1], 88
    s_load_dwordx2 s[32:33], s[0:1], 48
    s_load_dwordx2 s[16:17], s[0:1], 0
    s_load_dwordx2 s[20:21], s[0:1], 72
    v_and_b32 v1, 63, v0
    v_lshrrev_b32 v8, 6, v0
    v_lshlrev_b32 v12, 4, v0
    v_readfirstlane_b32 s5, v8
    s_and_b32 s6, s2, 7
    s_lshr_b32 s7, s2, 3
    s_lshr_b32 s3, s6, 1
    s_and_b32 s6, s6, 1
    s_lshl1_add_u32 s4, s7, s6
    v_mov_b32 v16, 0
    v_mov_b32 v17, 0
    v_mov_b32 v18, 0
    v_mov_b32 v19, 0
    v_mov_b32 v20, 0x271000
    v_mov_b32 v21, v20
    v_mov_b32 v22, v20
    v_mov_b32 v23, v20
    v_mov_b32 v24, 4640
    v_mov_b32 v25, v24
    v_mov_b32 v26, v24
    v_mov_b32 v27, v24
    ds_write_b128 v12, v[20:23] offset:5120
    ds_write_b128 v12, v[24:27] offset:21504
    v_cmp_gt_u32 vcc, 0x140, v0
    s_and_saveexec_b64 s[28:29], vcc
    ds_write_b128 v12, v[16:19]
    s_mov_b64 exec, s[28:29]
    v_lshlrev_b32 v124, 2, v1
    v_lshlrev_b32 v125, 5, v1
    v_lshlrev_b32 v123, 4, v1
    v_and_b32 v8, 15, v1
    v_lshrrev_b32 v9, 4, v1
    v_lshlrev_b32 v2, 4, v8
    v_lshlrev_b32 v118, 3, v9
    s_lshl_b32 s6, s3, 7
    v_lshlrev_b32 v127, 3, v8
    v_add_u32 v127, s6, v127
    v_lshl_add_u32 v10, v9, 11, v127
    v_mov_b32 v120, 1
    v_mul_u32_u24 v95, 2500, v1
    s_mov_b32 s10, 28387328
    s_mov_b32 s11, 0x20000
    s_mov_b32 s34, 8192
    s_mov_b32 s35, 0x20000
    s_lshl_b32 s6, s4, 8
    s_add_u32 s6, s6, 26241024
    s_and_b32 s7, s5, 7
    s_lshl_b32 s7, s7, 5
    v_and_b32 v94, 7, v1
    v_lshl_add_u32 v94, v94, 2, s7
    s_waitcnt lgkmcnt(0)
    buffer_load_dword v96, v124, s[8:11], s6 offen
    buffer_load_dwordx2 v[80:81], v10, s[32:35], 0 offen offset:0
    buffer_load_dwordx2 v[82:83], v10, s[32:35], 0 offen offset:512
    buffer_load_dwordx2 v[84:85], v10, s[32:35], 0 offen offset:1024
    buffer_load_dwordx2 v[86:87], v10, s[32:35], 0 offen offset:1536
    s_barrier
    s_mov_b32 s18, 5120000
    s_mov_b32 s19, 0x20000
    s_mov_b32 s22, 5120000
    s_mov_b32 s23, 0x20000
    s_mul_i32 s6, s3, 2560000
    s_add_u32 s6, s6, 10241024
    s_add_u32 s12, s8, s6
    s_addc_u32 s13, s9, 0
    s_mov_b32 s14, 2560000
    s_mov_b32 s15, 0x20000
    s_mul_i32 s24, s3, 2560256
    s_mov_b32 s65, 0xffff
    s_mov_b32 s68, 0x55555555
    s_mov_b32 s69, 0x55555555
    s_mul_i32 s6, s4, 157
    s_sub_u32 s6, 10000, s6
    s_min_u32 s6, s6, 157
    s_add_u32 s6, s6, 3
    s_lshr_b32 s6, s6, 2
    s_mov_b32 s64, 0
    s_cmp_lt_u32 s5, s6
    s_addc_u32 s64, s64, 0
    s_sub_u32 s7, 31, s5
    s_cmp_lt_u32 s7, s6
    s_addc_u32 s64, s64, 0
    s_add_u32 s7, s5, 32
    s_cmp_lt_u32 s7, s6
    s_addc_u32 s64, s64, 0
    s_waitcnt vmcnt(4)
    v_lshrrev_b32 v97, 16, v96
    v_and_b32 v99, 0xffff, v96
    v_mov_b32 v98, v97
    v_add_u32 v99, v99, v95
    s_nop 1
    v_add_u32_dpp v98, v98, v98 row_shr:1 row_mask:0xf bank_mask:0xf bound_ctrl:0
    s_nop 1
    v_add_u32_dpp v98, v98, v98 row_shr:2 row_mask:0xf bank_mask:0xf bound_ctrl:0
    s_nop 1
    v_add_u32_dpp v98, v98, v98 row_shr:4 row_mask:0xf bank_mask:0xf bound_ctrl:0
    s_nop 1
    v_add_u32_dpp v98, v98, v98 row_shr:8 row_mask:0xf bank_mask:0xf bound_ctrl:0
    s_nop 1
    v_add_u32_dpp v98, v98, v98 row_bcast:15 row_mask:0xa bank_mask:0xf
    s_nop 1
    v_add_u32_dpp v98, v98, v98 row_bcast:31 row_mask:0xc bank_mask:0xf
    s_nop 1
    v_readlane_b32 s25, v98, 63
    v_sub_u32 v98, v98, v97
    v_lshlrev_b32 v98, 5, v98
    v_add_u32 v98, 37888, v98
    s_cmp_ge_u32 s5, 8
    s_cbranch_scc1 K2_LPRE
    v_lshlrev_b32 v99, 2, v99
    v_add_u32 v99, 20481024, v99
    s_branch K2_LPRED
K2_LPRE:
    v_lshlrev_b32 v99, 5, v99
    v_add_u32 v99, 21121024, v99
    v_lshlrev_b32 v97, 1, v97
K2_LPRED:
    ds_bpermute_b32 v100, v94, v97
    ds_bpermute_b32 v101, v94, v99
    ds_bpermute_b32 v102, v94, v98
    v_lshrrev_b32 v103, 16, v96
    v_cmp_lt_u32 s[28:29], 64, v103
    s_cmp_gt_u32 s25, 3584
    s_cselect_b32 s26, 1, 0
    s_cbranch_scc1 K2_B3
    s_waitcnt lgkmcnt(0)
    v_readlane_b32 s36, v101, 0
    v_readlane_b32 s37, v101, 1
    v_readlane_b32 s38, v101, 2
    v_readlane_b32 s39, v101, 3
    v_readlane_b32 s40, v101, 4
    v_readlane_b32 s41, v101, 5
    v_readlane_b32 s42, v101, 6
    v_readlane_b32 s43, v101, 7
    v_readlane_b32 s44, v100, 0
    v_readlane_b32 s45, v100, 1
    v_readlane_b32 s46, v100, 2
    v_readlane_b32 s47, v100, 3
    v_readlane_b32 s48, v100, 4
    v_readlane_b32 s49, v100, 5
    v_readlane_b32 s50, v100, 6
    v_readlane_b32 s51, v100, 7
    v_readlane_b32 s52, v102, 0
    v_readlane_b32 s53, v102, 1
    v_readlane_b32 s54, v102, 2
    v_readlane_b32 s55, v102, 3
    v_readlane_b32 s56, v102, 4
    v_readlane_b32 s57, v102, 5
    v_readlane_b32 s58, v102, 6
    v_readlane_b32 s59, v102, 7
    s_cmp_ge_u32 s5, 8
    s_cbranch_scc1 K2_LOADER
    s_setprio 2
    buffer_load_dword v32, v124, s[8:11], s36 offen
    buffer_load_dword v33, v124, s[8:11], s37 offen
    buffer_load_dword v34, v124, s[8:11], s38 offen
    buffer_load_dword v35, v124, s[8:11], s39 offen
    buffer_load_dword v36, v124, s[8:11], s40 offen
    buffer_load_dword v37, v124, s[8:11], s41 offen
    buffer_load_dword v38, v124, s[8:11], s42 offen
    buffer_load_dword v39, v124, s[8:11], s43 offen
    v_cmp_gt_u32 s[84:85], s44, v1
    v_cmp_gt_u32 s[86:87], s45, v1
    v_cmp_gt_u32 s[88:89], s46, v1
    v_cmp_gt_u32 s[90:91], s47, v1
    v_cmp_gt_u32 s[92:93], s48, v1
    v_cmp_gt_u32 s[94:95], s49, v1
    v_cmp_gt_u32 s[96:97], s50, v1
    v_cmp_gt_u32 s[98:99], s51, v1
    s_waitcnt vmcnt(8)
    v_lshlrev_b32 v88, 16, v80
    v_mul_f32 v88, 0xbfb8aa3b, v88
    v_lshlrev_b32 v89, 16, v82
    v_mul_f32 v89, 0xbfb8aa3b, v89
    v_lshlrev_b32 v90, 16, v84
    v_mul_f32 v90, 0xbfb8aa3b, v90
    v_lshlrev_b32 v91, 16, v86
    v_mul_f32 v91, 0xbfb8aa3b, v91
    v_cvt_pk_bf16_f32 v16, v88, v89
    v_cvt_pk_bf16_f32 v17, v90, v91
    v_mov_b32 v18, 0xc1400000
    v_mov_b32 v19, 0
    v_and_b32 v88, 0xffff0000, v80
    v_mul_f32 v88, 0xbfb8aa3b, v88
    v_and_b32 v89, 0xffff0000, v82
    v_mul_f32 v89, 0xbfb8aa3b, v89
    v_and_b32 v90, 0xffff0000, v84
    v_mul_f32 v90, 0xbfb8aa3b, v90
    v_and_b32 v91, 0xffff0000, v86
    v_mul_f32 v91, 0xbfb8aa3b, v91
    v_cvt_pk_bf16_f32 v20, v88, v89
    v_cvt_pk_bf16_f32 v21, v90, v91
    v_mov_b32 v22, 0xc1400000
    v_mov_b32 v23, 0
    v_lshlrev_b32 v88, 16, v81
    v_mul_f32 v88, 0xbfb8aa3b, v88
    v_lshlrev_b32 v89, 16, v83
    v_mul_f32 v89, 0xbfb8aa3b, v89
    v_lshlrev_b32 v90, 16, v85
    v_mul_f32 v90, 0xbfb8aa3b, v90
    v_lshlrev_b32 v91, 16, v87
    v_mul_f32 v91, 0xbfb8aa3b, v91
    v_cvt_pk_bf16_f32 v24, v88, v89
    v_cvt_pk_bf16_f32 v25, v90, v91
    v_mov_b32 v26, 0xc1400000
    v_mov_b32 v27, 0
    v_and_b32 v88, 0xffff0000, v81
    v_mul_f32 v88, 0xbfb8aa3b, v88
    v_and_b32 v89, 0xffff0000, v83
    v_mul_f32 v89, 0xbfb8aa3b, v89
    v_and_b32 v90, 0xffff0000, v85
    v_mul_f32 v90, 0xbfb8aa3b, v90
    v_and_b32 v91, 0xffff0000, v87
    v_mul_f32 v91, 0xbfb8aa3b, v91
    v_cvt_pk_bf16_f32 v28, v88, v89
    v_cvt_pk_bf16_f32 v29, v90, v91
    v_mov_b32 v30, 0xc1400000
    v_mov_b32 v31, 0
    v_bfe_u32 v10, v1, 2, 2
    v_lshrrev_b32 v9, 4, v1
    v_cmp_eq_u32 vcc, v10, v9
    v_mov_b32 v10, 0x3f800000
    v_mov_b32 v11, 0x3f803f80
    v_cndmask_b32 v14, v10, v11, vcc
    v_mov_b32 v15, 0
    v_mov_b32 v6, 0x27800000
    v_mov_b32 v7, 0x27800000
    v_add_u32 v72, 768, v124
    s_waitcnt vmcnt(7)
    v_and_b32 v40, 0xff, v32
    v_lshlrev_b32 v40, 2, v40
    v_cndmask_b32 v40, v72, v40, s[84:85]
    ds_add_u32 v40, v120 offset:0
    s_waitcnt vmcnt(6)
    v_and_b32 v41, 0xff, v33
    v_lshlrev_b32 v41, 2, v41
    v_cndmask_b32 v41, v72, v41, s[86:87]
    ds_add_u32 v41, v120 offset:0
    s_waitcnt vmcnt(5)
    v_and_b32 v42, 0xff, v34
    v_lshlrev_b32 v42, 2, v42
    v_cndmask_b32 v42, v72, v42, s[88:89]
    ds_add_u32 v42, v120 offset:0
    s_waitcnt vmcnt(4)
    v_and_b32 v43, 0xff, v35
    v_lshlrev_b32 v43, 2, v43
    v_cndmask_b32 v43, v72, v43, s[90:91]
    ds_add_u32 v43, v120 offset:0
    s_waitcnt vmcnt(3)
    v_and_b32 v44, 0xff, v36
    v_lshlrev_b32 v44, 2, v44
    v_cndmask_b32 v44, v72, v44, s[92:93]
    ds_add_u32 v44, v120 offset:0
    s_waitcnt vmcnt(2)
    v_and_b32 v45, 0xff, v37
    v_lshlrev_b32 v45, 2, v45
    v_cndmask_b32 v45, v72, v45, s[94:95]
    ds_add_u32 v45, v120 offset:0
    s_waitcnt vmcnt(1)
    v_and_b32 v46, 0xff, v38
    v_lshlrev_b32 v46, 2, v46
    v_cndmask_b32 v46, v72, v46, s[96:97]
    ds_add_u32 v46, v120 offset:0
    s_waitcnt vmcnt(0)
    v_and_b32 v47, 0xff, v39
    v_lshlrev_b32 v47, 2, v47
    v_cndmask_b32 v47, v72, v47, s[98:99]
    ds_add_u32 v47, v120 offset:0
    s_cmp_eq_u64 s[28:29], 0
    s_cbranch_scc1 K2_P1XD
    s_mov_b32 s79, 64
K2_P1X:
    s_mov_b32 s78, 0
    s_sub_i32 s6, s44, s79
    s_max_i32 s78, s78, s6
    v_cmp_gt_i32 vcc, s6, v1
    s_lshl_b32 s7, s79, 2
    s_add_u32 s7, s7, s36
    buffer_load_dword v73, v124, s[8:11], s7 offen
    s_waitcnt vmcnt(0)
    v_and_b32 v73, 0xff, v73
    v_lshlrev_b32 v73, 2, v73
    v_cndmask_b32 v73, v72, v73, vcc
    ds_add_u32 v73, v120 offset:0
    s_sub_i32 s6, s45, s79
    s_max_i32 s78, s78, s6
    v_cmp_gt_i32 vcc, s6, v1
    s_lshl_b32 s7, s79, 2
    s_add_u32 s7, s7, s37
    buffer_load_dword v73, v124, s[8:11], s7 offen
    s_waitcnt vmcnt(0)
    v_and_b32 v73, 0xff, v73
    v_lshlrev_b32 v73, 2, v73
    v_cndmask_b32 v73, v72, v73, vcc
    ds_add_u32 v73, v120 offset:0
    s_sub_i32 s6, s46, s79
    s_max_i32 s78, s78, s6
    v_cmp_gt_i32 vcc, s6, v1
    s_lshl_b32 s7, s79, 2
    s_add_u32 s7, s7, s38
    buffer_load_dword v73, v124, s[8:11], s7 offen
    s_waitcnt vmcnt(0)
    v_and_b32 v73, 0xff, v73
    v_lshlrev_b32 v73, 2, v73
    v_cndmask_b32 v73, v72, v73, vcc
    ds_add_u32 v73, v120 offset:0
    s_sub_i32 s6, s47, s79
    s_max_i32 s78, s78, s6
    v_cmp_gt_i32 vcc, s6, v1
    s_lshl_b32 s7, s79, 2
    s_add_u32 s7, s7, s39
    buffer_load_dword v73, v124, s[8:11], s7 offen
    s_waitcnt vmcnt(0)
    v_and_b32 v73, 0xff, v73
    v_lshlrev_b32 v73, 2, v73
    v_cndmask_b32 v73, v72, v73, vcc
    ds_add_u32 v73, v120 offset:0
    s_sub_i32 s6, s48, s79
    s_max_i32 s78, s78, s6
    v_cmp_gt_i32 vcc, s6, v1
    s_lshl_b32 s7, s79, 2
    s_add_u32 s7, s7, s40
    buffer_load_dword v73, v124, s[8:11], s7 offen
    s_waitcnt vmcnt(0)
    v_and_b32 v73, 0xff, v73
    v_lshlrev_b32 v73, 2, v73
    v_cndmask_b32 v73, v72, v73, vcc
    ds_add_u32 v73, v120 offset:0
    s_sub_i32 s6, s49, s79
    s_max_i32 s78, s78, s6
    v_cmp_gt_i32 vcc, s6, v1
    s_lshl_b32 s7, s79, 2
    s_add_u32 s7, s7, s41
    buffer_load_dword v73, v124, s[8:11], s7 offen
    s_waitcnt vmcnt(0)
    v_and_b32 v73, 0xff, v73
    v_lshlrev_b32 v73, 2, v73
    v_cndmask_b32 v73, v72, v73, vcc
    ds_add_u32 v73, v120 offset:0
    s_sub_i32 s6, s50, s79
    s_max_i32 s78, s78, s6
    v_cmp_gt_i32 vcc, s6, v1
    s_lshl_b32 s7, s79, 2
    s_add_u32 s7, s7, s42
    buffer_load_dword v73, v124, s[8:11], s7 offen
    s_waitcnt vmcnt(0)
    v_and_b32 v73, 0xff, v73
    v_lshlrev_b32 v73, 2, v73
    v_cndmask_b32 v73, v72, v73, vcc
    ds_add_u32 v73, v120 offset:0
    s_sub_i32 s6, s51, s79
    s_max_i32 s78, s78, s6
    v_cmp_gt_i32 vcc, s6, v1
    s_lshl_b32 s7, s79, 2
    s_add_u32 s7, s7, s43
    buffer_load_dword v73, v124, s[8:11], s7 offen
    s_waitcnt vmcnt(0)
    v_and_b32 v73, 0xff, v73
    v_lshlrev_b32 v73, 2, v73
    v_cndmask_b32 v73, v72, v73, vcc
    ds_add_u32 v73, v120 offset:0
    s_add_u32 s79, s79, 64
    s_cmp_gt_i32 s78, 64
    s_cbranch_scc1 K2_P1X
K2_P1XD:
    s_waitcnt lgkmcnt(0)
    v_mov_b32 v122, 4612
    s_mov_b64 exec, 1
    ds_add_u32 v122, v120
    s_mov_b64 exec, -1
    s_cmp_lg_u32 s5, 0
    s_cbranch_scc1 K2_NODE_DONE
    v_mov_b32 v122, 4612
K2_Wa:
    ds_read_b32 v121, v122
    s_waitcnt lgkmcnt(0)
    v_cmp_le_u32 vcc, 8, v121
    s_cbranch_vccnz K2_WDa
    s_sleep 1
    s_branch K2_Wa
K2_WDa:
    ds_read_b32 v96, v124 offset:0
    ds_read_b32 v97, v124 offset:256
    ds_read_b32 v98, v124 offset:512
    s_mul_i32 s82, s4, 157
    s_sub_u32 s7, 10000, s82
    s_min_u32 s7, s7, 157
    v_add_u32 v114, 0, v1
    v_add_u32 v115, 64, v1
    v_add_u32 v116, 128, v1
    s_waitcnt lgkmcnt(0)
    v_add_u32 v99, 1, v96
    v_lshrrev_b32 v99, 1, v99
    v_min_u32 v102, 62, v99
    v_lshl_add_u32 v102, v102, 2, 4
    v_cmp_gt_u32 vcc, s7, v114
    v_add_u32 v108, s82, v114
    v_mov_b32 v117, 0x2710
    v_cndmask_b32 v102, 0, v102, vcc
    v_cndmask_b32 v96, v117, v108, vcc
    ds_add_rtn_u32 v105, v102, v120 offset:2048
    v_add_u32 v100, 1, v97
    v_lshrrev_b32 v100, 1, v100
    v_min_u32 v103, 62, v100
    v_lshl_add_u32 v103, v103, 2, 4
    v_cmp_gt_u32 vcc, s7, v115
    v_add_u32 v109, s82, v115
    v_mov_b32 v117, 0x2710
    v_cndmask_b32 v103, 0, v103, vcc
    v_cndmask_b32 v97, v117, v109, vcc
    ds_add_rtn_u32 v106, v103, v120 offset:2048
    v_add_u32 v101, 1, v98
    v_lshrrev_b32 v101, 1, v101
    v_min_u32 v104, 62, v101
    v_lshl_add_u32 v104, v104, 2, 4
    v_cmp_gt_u32 vcc, s7, v116
    v_add_u32 v110, s82, v116
    v_mov_b32 v117, 0x2710
    v_cndmask_b32 v104, 0, v104, vcc
    v_cndmask_b32 v98, v117, v110, vcc
    ds_add_rtn_u32 v107, v104, v120 offset:2048
    v_sub_u32 v108, 252, v124
    s_waitcnt lgkmcnt(0)
    ds_read_b32 v109, v108 offset:2048
    v_sub_u32 v102, 252, v102
    v_sub_u32 v103, 252, v103
    v_sub_u32 v104, 252, v104
    s_waitcnt lgkmcnt(0)
    v_mov_b32 v110, v109
    s_nop 1
    v_add_u32_dpp v110, v110, v110 row_shr:1 row_mask:0xf bank_mask:0xf bound_ctrl:0
    s_nop 1
    v_add_u32_dpp v110, v110, v110 row_shr:2 row_mask:0xf bank_mask:0xf bound_ctrl:0
    s_nop 1
    v_add_u32_dpp v110, v110, v110 row_shr:4 row_mask:0xf bank_mask:0xf bound_ctrl:0
    s_nop 1
    v_add_u32_dpp v110, v110, v110 row_shr:8 row_mask:0xf bank_mask:0xf bound_ctrl:0
    s_nop 1
    v_add_u32_dpp v110, v110, v110 row_bcast:15 row_mask:0xa bank_mask:0xf
    s_nop 1
    v_add_u32_dpp v110, v110, v110 row_bcast:31 row_mask:0xc bank_mask:0xf
    s_nop 1
    v_sub_u32 v110, v110, v109
    s_nop 0
    ds_bpermute_b32 v111, v102, v110
    ds_bpermute_b32 v112, v103, v110
    ds_bpermute_b32 v113, v104, v110
    s_waitcnt lgkmcnt(0)
    v_add_u32 v111, v111, v105
    v_lshrrev_b32 v114, 2, v111
    v_and_b32 v105, 3, v111
    v_lshrrev_b32 v115, 4, v114
    v_and_b32 v114, 15, v114
    v_bfe_i32 v116, v115, 0, 1
    v_and_b32 v116, 15, v116
    v_xor_b32 v114, v114, v116
    v_mad_u32_u24 v114, v114, 3, v115
    v_lshlrev_b32 v102, 2, v114
    ds_max_u32 v102, v99 offset:2304
    v_add_lshl_u32 v116, v102, v105, 2
    ds_write_b32 v116, v96 offset:3840
    v_add_u32 v112, v112, v106
    v_lshrrev_b32 v114, 2, v112
    v_and_b32 v106, 3, v112
    v_lshrrev_b32 v115, 4, v114
    v_and_b32 v114, 15, v114
    v_bfe_i32 v116, v115, 0, 1
    v_and_b32 v116, 15, v116
    v_xor_b32 v114, v114, v116
    v_mad_u32_u24 v114, v114, 3, v115
    v_lshlrev_b32 v103, 2, v114
    ds_max_u32 v103, v100 offset:2304
    v_add_lshl_u32 v116, v103, v106, 2
    ds_write_b32 v116, v97 offset:3840
    v_add_u32 v113, v113, v107
    v_lshrrev_b32 v114, 2, v113
    v_and_b32 v107, 3, v113
    v_lshrrev_b32 v115, 4, v114
    v_and_b32 v114, 15, v114
    v_bfe_i32 v116, v115, 0, 1
    v_and_b32 v116, 15, v116
    v_xor_b32 v114, v114, v116
    v_mad_u32_u24 v114, v114, 3, v115
    v_lshlrev_b32 v104, 2, v114
    ds_max_u32 v104, v101 offset:2304
    v_add_lshl_u32 v116, v104, v107, 2
    ds_write_b32 v116, v98 offset:3840
    s_waitcnt lgkmcnt(0)
    ds_read_b32 v108, v124 offset:2304
    s_waitcnt lgkmcnt(0)
    v_add_u32 v108, 1, v108
    v_lshrrev_b32 v108, 1, v108
    v_mov_b32 v109, v108
    s_nop 1
    v_add_u32_dpp v109, v109, v109 row_shr:1 row_mask:0xf bank_mask:0xf bound_ctrl:0
    s_nop 1
    v_add_u32_dpp v109, v109, v109 row_shr:2 row_mask:0xf bank_mask:0xf bound_ctrl:0
    s_nop 1
    v_add_u32_dpp v109, v109, v109 row_shr:4 row_mask:0xf bank_mask:0xf bound_ctrl:0
    s_nop 1
    v_add_u32_dpp v109, v109, v109 row_shr:8 row_mask:0xf bank_mask:0xf bound_ctrl:0
    s_nop 1
    v_add_u32_dpp v109, v109, v109 row_bcast:15 row_mask:0xa bank_mask:0xf
    s_nop 1
    v_add_u32_dpp v109, v109, v109 row_bcast:31 row_mask:0xc bank_mask:0xf
    s_nop 1
    v_readlane_b32 s6, v109, 63
    v_sub_u32 v109, v109, v108
    ds_write_b32 v124, v109 offset:3584
    ds_bpermute_b32 v111, v102, v109
    ds_bpermute_b32 v112, v103, v109
    ds_bpermute_b32 v113, v104, v109
    s_cmp_gt_u32 s6, 240
    s_cselect_b32 s6, 1, 0
    v_mov_b32 v108, s6
    v_mov_b32 v110, 4608
    ds_write_b32 v110, v108
    s_waitcnt lgkmcnt(1)
    v_lshlrev_b32 v111, 4, v111
    v_lshl_add_u32 v111, v105, 2, v111
    ds_write_b32 v124, v111 offset:2560
    v_lshlrev_b32 v112, 4, v112
    v_lshl_add_u32 v112, v106, 2, v112
    ds_write_b32 v124, v112 offset:2816
    v_lshlrev_b32 v113, 4, v113
    v_lshl_add_u32 v113, v107, 2, v113
    ds_write_b32 v124, v113 offset:3072
    s_waitcnt lgkmcnt(0)
    v_mov_b32 v122, 4616
    s_mov_b64 exec, 1
    ds_add_u32 v122, v120
    s_mov_b64 exec, -1
K2_NODE_DONE:
    v_mov_b32 v122, 4616
K2_Wb:
    ds_read_b32 v121, v122
    s_waitcnt lgkmcnt(0)
    v_cmp_le_u32 vcc, 1, v121
    s_cbranch_vccnz K2_WDb
    s_sleep 1
    s_branch K2_Wb
K2_WDb:
    v_mov_b32 v110, 4608
    ds_read_b32 v108, v110
    s_waitcnt lgkmcnt(0)
    v_cmp_ne_u32 vcc, 0, v108
    s_cbranch_vccnz K2_B3P
    ds_add_rtn_u32 v48, v40, v120 offset:1024
    ds_read_b32 v56, v40 offset:2560
    ds_add_rtn_u32 v49, v41, v120 offset:1024
    ds_read_b32 v57, v41 offset:2560
    ds_add_rtn_u32 v50, v42, v120 offset:1024
    ds_read_b32 v58, v42 offset:2560
    ds_add_rtn_u32 v51, v43, v120 offset:1024
    ds_read_b32 v59, v43 offset:2560
    ds_add_rtn_u32 v52, v44, v120 offset:1024
    ds_read_b32 v60, v44 offset:2560
    ds_add_rtn_u32 v53, v45, v120 offset:1024
    ds_read_b32 v61, v45 offset:2560
    ds_add_rtn_u32 v54, v46, v120 offset:1024
    ds_read_b32 v62, v46 offset:2560
    ds_add_rtn_u32 v55, v47, v120 offset:1024
    ds_read_b32 v63, v47 offset:2560
    v_add_u32 v64, s52, v125
    v_and_b32 v32, 0xffffff00, v32
    v_add_u32 v65, s53, v125
    v_and_b32 v33, 0xffffff00, v33
    v_add_u32 v66, s54, v125
    v_and_b32 v34, 0xffffff00, v34
    v_add_u32 v67, s55, v125
    v_and_b32 v35, 0xffffff00, v35
    v_add_u32 v68, s56, v125
    v_and_b32 v36, 0xffffff00, v36
    v_add_u32 v69, s57, v125
    v_and_b32 v37, 0xffffff00, v37
    v_add_u32 v70, s58, v125
    v_and_b32 v38, 0xffffff00, v38
    v_add_u32 v71, s59, v125
    v_and_b32 v39, 0xffffff00, v39
    s_waitcnt lgkmcnt(14)
    v_lshrrev_b32 v121, 2, v48
    v_mad_u32_u24 v121, v121, 12, v48
    v_add_lshl_u32 v48, v121, v56, 2
    s_waitcnt lgkmcnt(12)
    v_lshrrev_b32 v121, 2, v49
    v_mad_u32_u24 v121, v121, 12, v49
    v_add_lshl_u32 v49, v121, v57, 2
    s_waitcnt lgkmcnt(10)
    v_lshrrev_b32 v121, 2, v50
    v_mad_u32_u24 v121, v121, 12, v50
    v_add_lshl_u32 v50, v121, v58, 2
    s_waitcnt lgkmcnt(8)
    v_lshrrev_b32 v121, 2, v51
    v_mad_u32_u24 v121, v121, 12, v51
    v_add_lshl_u32 v51, v121, v59, 2
    s_waitcnt lgkmcnt(6)
    v_lshrrev_b32 v121, 2, v52
    v_mad_u32_u24 v121, v121, 12, v52
    v_add_lshl_u32 v52, v121, v60, 2
    s_waitcnt lgkmcnt(4)
    v_lshrrev_b32 v121, 2, v53
    v_mad_u32_u24 v121, v121, 12, v53
    v_add_lshl_u32 v53, v121, v61, 2
    s_waitcnt lgkmcnt(2)
    v_lshrrev_b32 v121, 2, v54
    v_mad_u32_u24 v121, v121, 12, v54
    v_add_lshl_u32 v54, v121, v62, 2
    s_waitcnt lgkmcnt(0)
    v_lshrrev_b32 v121, 2, v55
    v_mad_u32_u24 v121, v121, 12, v55
    v_add_lshl_u32 v55, v121, v63, 2
    s_mov_b64 exec, s[84:85]
    ds_write_b32 v48, v32 offset:5120
    ds_write_b32 v48, v64 offset:21504
    s_mov_b64 exec, s[86:87]
    ds_write_b32 v49, v33 offset:5120
    ds_write_b32 v49, v65 offset:21504
    s_mov_b64 exec, s[88:89]
    ds_write_b32 v50, v34 offset:5120
    ds_write_b32 v50, v66 offset:21504
    s_mov_b64 exec, s[90:91]
    ds_write_b32 v51, v35 offset:5120
    ds_write_b32 v51, v67 offset:21504
    s_mov_b64 exec, s[92:93]
    ds_write_b32 v52, v36 offset:5120
    ds_write_b32 v52, v68 offset:21504
    s_mov_b64 exec, s[94:95]
    ds_write_b32 v53, v37 offset:5120
    ds_write_b32 v53, v69 offset:21504
    s_mov_b64 exec, s[96:97]
    ds_write_b32 v54, v38 offset:5120
    ds_write_b32 v54, v70 offset:21504
    s_mov_b64 exec, s[98:99]
    ds_write_b32 v55, v39 offset:5120
    ds_write_b32 v55, v71 offset:21504
    s_mov_b64 exec, -1
    s_cmp_eq_u64 s[28:29], 0
    s_cbranch_scc1 K2_B3P
    s_mov_b32 s79, 64
K2_P2X:
    s_waitcnt lgkmcnt(0)
    s_mov_b32 s78, 0
    s_sub_i32 s81, s44, s79
    s_max_i32 s78, s78, s81
    v_cmp_gt_i32 s[84:85], s81, v1
    s_lshl_b32 s7, s79, 2
    s_add_u32 s7, s7, s36
    buffer_load_dword v32, v124, s[8:11], s7 offen
    s_sub_i32 s81, s45, s79
    s_max_i32 s78, s78, s81
    v_cmp_gt_i32 s[86:87], s81, v1
    s_lshl_b32 s7, s79, 2
    s_add_u32 s7, s7, s37
    buffer_load_dword v33, v124, s[8:11], s7 offen
    s_sub_i32 s81, s46, s79
    s_max_i32 s78, s78, s81
    v_cmp_gt_i32 s[88:89], s81, v1
    s_lshl_b32 s7, s79, 2
    s_add_u32 s7, s7, s38
    buffer_load_dword v34, v124, s[8:11], s7 offen
    s_sub_i32 s81, s47, s79
    s_max_i32 s78, s78, s81
    v_cmp_gt_i32 s[90:91], s81, v1
    s_lshl_b32 s7, s79, 2
    s_add_u32 s7, s7, s39
    buffer_load_dword v35, v124, s[8:11], s7 offen
    s_sub_i32 s81, s48, s79
    s_max_i32 s78, s78, s81
    v_cmp_gt_i32 s[92:93], s81, v1
    s_lshl_b32 s7, s79, 2
    s_add_u32 s7, s7, s40
    buffer_load_dword v36, v124, s[8:11], s7 offen
    s_sub_i32 s81, s49, s79
    s_max_i32 s78, s78, s81
    v_cmp_gt_i32 s[94:95], s81, v1
    s_lshl_b32 s7, s79, 2
    s_add_u32 s7, s7, s41
    buffer_load_dword v37, v124, s[8:11], s7 offen
    s_sub_i32 s81, s50, s79
    s_max_i32 s78, s78, s81
    v_cmp_gt_i32 s[96:97], s81, v1
    s_lshl_b32 s7, s79, 2
    s_add_u32 s7, s7, s42
    buffer_load_dword v38, v124, s[8:11], s7 offen
    s_sub_i32 s81, s51, s79
    s_max_i32 s78, s78, s81
    v_cmp_gt_i32 s[98:99], s81, v1
    s_lshl_b32 s7, s79, 2
    s_add_u32 s7, s7, s43
    buffer_load_dword v39, v124, s[8:11], s7 offen
    s_waitcnt vmcnt(0)
    v_and_b32 v40, 0xff, v32
    v_lshlrev_b32 v40, 2, v40
    v_cndmask_b32 v40, v72, v40, s[84:85]
    v_and_b32 v41, 0xff, v33
    v_lshlrev_b32 v41, 2, v41
    v_cndmask_b32 v41, v72, v41, s[86:87]
    v_and_b32 v42, 0xff, v34
    v_lshlrev_b32 v42, 2, v42
    v_cndmask_b32 v42, v72, v42, s[88:89]
    v_and_b32 v43, 0xff, v35
    v_lshlrev_b32 v43, 2, v43
    v_cndmask_b32 v43, v72, v43, s[90:91]
    v_and_b32 v44, 0xff, v36
    v_lshlrev_b32 v44, 2, v44
    v_cndmask_b32 v44, v72, v44, s[92:93]
    v_and_b32 v45, 0xff, v37
    v_lshlrev_b32 v45, 2, v45
    v_cndmask_b32 v45, v72, v45, s[94:95]
    v_and_b32 v46, 0xff, v38
    v_lshlrev_b32 v46, 2, v46
    v_cndmask_b32 v46, v72, v46, s[96:97]
    v_and_b32 v47, 0xff, v39
    v_lshlrev_b32 v47, 2, v47
    v_cndmask_b32 v47, v72, v47, s[98:99]
    s_lshl_b32 s80, s79, 5
    ds_add_rtn_u32 v48, v40, v120 offset:1024
    ds_read_b32 v56, v40 offset:2560
    ds_add_rtn_u32 v49, v41, v120 offset:1024
    ds_read_b32 v57, v41 offset:2560
    ds_add_rtn_u32 v50, v42, v120 offset:1024
    ds_read_b32 v58, v42 offset:2560
    ds_add_rtn_u32 v51, v43, v120 offset:1024
    ds_read_b32 v59, v43 offset:2560
    ds_add_rtn_u32 v52, v44, v120 offset:1024
    ds_read_b32 v60, v44 offset:2560
    ds_add_rtn_u32 v53, v45, v120 offset:1024
    ds_read_b32 v61, v45 offset:2560
    ds_add_rtn_u32 v54, v46, v120 offset:1024
    ds_read_b32 v62, v46 offset:2560
    ds_add_rtn_u32 v55, v47, v120 offset:1024
    ds_read_b32 v63, v47 offset:2560
    v_add_u32 v64, s52, v125
    v_add_u32 v64, s80, v64
    v_and_b32 v32, 0xffffff00, v32
    v_add_u32 v65, s53, v125
    v_add_u32 v65, s80, v65
    v_and_b32 v33, 0xffffff00, v33
    v_add_u32 v66, s54, v125
    v_add_u32 v66, s80, v66
    v_and_b32 v34, 0xffffff00, v34
    v_add_u32 v67, s55, v125
    v_add_u32 v67, s80, v67
    v_and_b32 v35, 0xffffff00, v35
    v_add_u32 v68, s56, v125
    v_add_u32 v68, s80, v68
    v_and_b32 v36, 0xffffff00, v36
    v_add_u32 v69, s57, v125
    v_add_u32 v69, s80, v69
    v_and_b32 v37, 0xffffff00, v37
    v_add_u32 v70, s58, v125
    v_add_u32 v70, s80, v70
    v_and_b32 v38, 0xffffff00, v38
    v_add_u32 v71, s59, v125
    v_add_u32 v71, s80, v71
    v_and_b32 v39, 0xffffff00, v39
    s_waitcnt lgkmcnt(14)
    v_lshrrev_b32 v121, 2, v48
    v_mad_u32_u24 v121, v121, 12, v48
    v_add_lshl_u32 v48, v121, v56, 2
    s_waitcnt lgkmcnt(12)
    v_lshrrev_b32 v121, 2, v49
    v_mad_u32_u24 v121, v121, 12, v49
    v_add_lshl_u32 v49, v121, v57, 2
    s_waitcnt lgkmcnt(10)
    v_lshrrev_b32 v121, 2, v50
    v_mad_u32_u24 v121, v121, 12, v50
    v_add_lshl_u32 v50, v121, v58, 2
    s_waitcnt lgkmcnt(8)
    v_lshrrev_b32 v121, 2, v51
    v_mad_u32_u24 v121, v121, 12, v51
    v_add_lshl_u32 v51, v121, v59, 2
    s_waitcnt lgkmcnt(6)
    v_lshrrev_b32 v121, 2, v52
    v_mad_u32_u24 v121, v121, 12, v52
    v_add_lshl_u32 v52, v121, v60, 2
    s_waitcnt lgkmcnt(4)
    v_lshrrev_b32 v121, 2, v53
    v_mad_u32_u24 v121, v121, 12, v53
    v_add_lshl_u32 v53, v121, v61, 2
    s_waitcnt lgkmcnt(2)
    v_lshrrev_b32 v121, 2, v54
    v_mad_u32_u24 v121, v121, 12, v54
    v_add_lshl_u32 v54, v121, v62, 2
    s_waitcnt lgkmcnt(0)
    v_lshrrev_b32 v121, 2, v55
    v_mad_u32_u24 v121, v121, 12, v55
    v_add_lshl_u32 v55, v121, v63, 2
    s_mov_b64 exec, s[84:85]
    ds_write_b32 v48, v32 offset:5120
    ds_write_b32 v48, v64 offset:21504
    s_mov_b64 exec, s[86:87]
    ds_write_b32 v49, v33 offset:5120
    ds_write_b32 v49, v65 offset:21504
    s_mov_b64 exec, s[88:89]
    ds_write_b32 v50, v34 offset:5120
    ds_write_b32 v50, v66 offset:21504
    s_mov_b64 exec, s[90:91]
    ds_write_b32 v51, v35 offset:5120
    ds_write_b32 v51, v67 offset:21504
    s_mov_b64 exec, s[92:93]
    ds_write_b32 v52, v36 offset:5120
    ds_write_b32 v52, v68 offset:21504
    s_mov_b64 exec, s[94:95]
    ds_write_b32 v53, v37 offset:5120
    ds_write_b32 v53, v69 offset:21504
    s_mov_b64 exec, s[96:97]
    ds_write_b32 v54, v38 offset:5120
    ds_write_b32 v54, v70 offset:21504
    s_mov_b64 exec, s[98:99]
    ds_write_b32 v55, v39 offset:5120
    ds_write_b32 v55, v71 offset:21504
    s_mov_b64 exec, -1
    s_add_u32 s79, s79, 64
    s_cmp_gt_i32 s78, 64
    s_cbranch_scc1 K2_P2X
    s_branch K2_B3P
K2_LOADER:
    v_add_u32 v103, 64, v1
    s_mov_b32 m0, s52
    v_cmp_gt_i32 vcc, s44, v1
    s_mov_b64 exec, vcc
    buffer_load_dwordx4 v123, s[8:11], s36 offen lds
    v_cmp_gt_i32 vcc, s44, v103
    s_mov_b64 exec, vcc
    buffer_load_dwordx4 v123, s[8:11], s36 offen offset:1024 lds
    s_mov_b64 exec, -1
    s_mov_b32 m0, s53
    v_cmp_gt_i32 vcc, s45, v1
    s_mov_b64 exec, vcc
    buffer_load_dwordx4 v123, s[8:11], s37 offen lds
    v_cmp_gt_i32 vcc, s45, v103
    s_mov_b64 exec, vcc
    buffer_load_dwordx4 v123, s[8:11], s37 offen offset:1024 lds
    s_mov_b64 exec, -1
    s_mov_b32 m0, s54
    v_cmp_gt_i32 vcc, s46, v1
    s_mov_b64 exec, vcc
    buffer_load_dwordx4 v123, s[8:11], s38 offen lds
    v_cmp_gt_i32 vcc, s46, v103
    s_mov_b64 exec, vcc
    buffer_load_dwordx4 v123, s[8:11], s38 offen offset:1024 lds
    s_mov_b64 exec, -1
    s_mov_b32 m0, s55
    v_cmp_gt_i32 vcc, s47, v1
    s_mov_b64 exec, vcc
    buffer_load_dwordx4 v123, s[8:11], s39 offen lds
    v_cmp_gt_i32 vcc, s47, v103
    s_mov_b64 exec, vcc
    buffer_load_dwordx4 v123, s[8:11], s39 offen offset:1024 lds
    s_mov_b64 exec, -1
    s_mov_b32 m0, s56
    v_cmp_gt_i32 vcc, s48, v1
    s_mov_b64 exec, vcc
    buffer_load_dwordx4 v123, s[8:11], s40 offen lds
    v_cmp_gt_i32 vcc, s48, v103
    s_mov_b64 exec, vcc
    buffer_load_dwordx4 v123, s[8:11], s40 offen offset:1024 lds
    s_mov_b64 exec, -1
    s_mov_b32 m0, s57
    v_cmp_gt_i32 vcc, s49, v1
    s_mov_b64 exec, vcc
    buffer_load_dwordx4 v123, s[8:11], s41 offen lds
    v_cmp_gt_i32 vcc, s49, v103
    s_mov_b64 exec, vcc
    buffer_load_dwordx4 v123, s[8:11], s41 offen offset:1024 lds
    s_mov_b64 exec, -1
    s_mov_b32 m0, s58
    v_cmp_gt_i32 vcc, s50, v1
    s_mov_b64 exec, vcc
    buffer_load_dwordx4 v123, s[8:11], s42 offen lds
    v_cmp_gt_i32 vcc, s50, v103
    s_mov_b64 exec, vcc
    buffer_load_dwordx4 v123, s[8:11], s42 offen offset:1024 lds
    s_mov_b64 exec, -1
    s_mov_b32 m0, s59
    v_cmp_gt_i32 vcc, s51, v1
    s_mov_b64 exec, vcc
    buffer_load_dwordx4 v123, s[8:11], s43 offen lds
    v_cmp_gt_i32 vcc, s51, v103
    s_mov_b64 exec, vcc
    buffer_load_dwordx4 v123, s[8:11], s43 offen offset:1024 lds
    s_mov_b64 exec, -1
    s_cmp_eq_u64 s[28:29], 0
    s_cbranch_scc1 K2_LDD
    s_mov_b32 s79, 64
K2_LDX:
    s_mov_b32 s78, 0
    s_lshl_b32 s7, s79, 1
    s_sub_i32 s81, s44, s7
    s_max_i32 s78, s78, s81
    s_lshl_b32 s7, s79, 5
    s_add_u32 s82, s7, s36
    s_add_u32 s83, s7, s52
    s_mov_b32 m0, s83
    v_cmp_gt_i32 vcc, s81, v1
    s_mov_b64 exec, vcc
    buffer_load_dwordx4 v123, s[8:11], s82 offen lds
    v_cmp_gt_i32 vcc, s81, v103
    s_mov_b64 exec, vcc
    buffer_load_dwordx4 v123, s[8:11], s82 offen offset:1024 lds
    s_mov_b64 exec, -1
    s_lshl_b32 s7, s79, 1
    s_sub_i32 s81, s45, s7
    s_max_i32 s78, s78, s81
    s_lshl_b32 s7, s79, 5
    s_add_u32 s82, s7, s37
    s_add_u32 s83, s7, s53
    s_mov_b32 m0, s83
    v_cmp_gt_i32 vcc, s81, v1
    s_mov_b64 exec, vcc
    buffer_load_dwordx4 v123, s[8:11], s82 offen lds
    v_cmp_gt_i32 vcc, s81, v103
    s_mov_b64 exec, vcc
    buffer_load_dwordx4 v123, s[8:11], s82 offen offset:1024 lds
    s_mov_b64 exec, -1
    s_lshl_b32 s7, s79, 1
    s_sub_i32 s81, s46, s7
    s_max_i32 s78, s78, s81
    s_lshl_b32 s7, s79, 5
    s_add_u32 s82, s7, s38
    s_add_u32 s83, s7, s54
    s_mov_b32 m0, s83
    v_cmp_gt_i32 vcc, s81, v1
    s_mov_b64 exec, vcc
    buffer_load_dwordx4 v123, s[8:11], s82 offen lds
    v_cmp_gt_i32 vcc, s81, v103
    s_mov_b64 exec, vcc
    buffer_load_dwordx4 v123, s[8:11], s82 offen offset:1024 lds
    s_mov_b64 exec, -1
    s_lshl_b32 s7, s79, 1
    s_sub_i32 s81, s47, s7
    s_max_i32 s78, s78, s81
    s_lshl_b32 s7, s79, 5
    s_add_u32 s82, s7, s39
    s_add_u32 s83, s7, s55
    s_mov_b32 m0, s83
    v_cmp_gt_i32 vcc, s81, v1
    s_mov_b64 exec, vcc
    buffer_load_dwordx4 v123, s[8:11], s82 offen lds
    v_cmp_gt_i32 vcc, s81, v103
    s_mov_b64 exec, vcc
    buffer_load_dwordx4 v123, s[8:11], s82 offen offset:1024 lds
    s_mov_b64 exec, -1
    s_lshl_b32 s7, s79, 1
    s_sub_i32 s81, s48, s7
    s_max_i32 s78, s78, s81
    s_lshl_b32 s7, s79, 5
    s_add_u32 s82, s7, s40
    s_add_u32 s83, s7, s56
    s_mov_b32 m0, s83
    v_cmp_gt_i32 vcc, s81, v1
    s_mov_b64 exec, vcc
    buffer_load_dwordx4 v123, s[8:11], s82 offen lds
    v_cmp_gt_i32 vcc, s81, v103
    s_mov_b64 exec, vcc
    buffer_load_dwordx4 v123, s[8:11], s82 offen offset:1024 lds
    s_mov_b64 exec, -1
    s_lshl_b32 s7, s79, 1
    s_sub_i32 s81, s49, s7
    s_max_i32 s78, s78, s81
    s_lshl_b32 s7, s79, 5
    s_add_u32 s82, s7, s41
    s_add_u32 s83, s7, s57
    s_mov_b32 m0, s83
    v_cmp_gt_i32 vcc, s81, v1
    s_mov_b64 exec, vcc
    buffer_load_dwordx4 v123, s[8:11], s82 offen lds
    v_cmp_gt_i32 vcc, s81, v103
    s_mov_b64 exec, vcc
    buffer_load_dwordx4 v123, s[8:11], s82 offen offset:1024 lds
    s_mov_b64 exec, -1
    s_lshl_b32 s7, s79, 1
    s_sub_i32 s81, s50, s7
    s_max_i32 s78, s78, s81
    s_lshl_b32 s7, s79, 5
    s_add_u32 s82, s7, s42
    s_add_u32 s83, s7, s58
    s_mov_b32 m0, s83
    v_cmp_gt_i32 vcc, s81, v1
    s_mov_b64 exec, vcc
    buffer_load_dwordx4 v123, s[8:11], s82 offen lds
    v_cmp_gt_i32 vcc, s81, v103
    s_mov_b64 exec, vcc
    buffer_load_dwordx4 v123, s[8:11], s82 offen offset:1024 lds
    s_mov_b64 exec, -1
    s_lshl_b32 s7, s79, 1
    s_sub_i32 s81, s51, s7
    s_max_i32 s78, s78, s81
    s_lshl_b32 s7, s79, 5
    s_add_u32 s82, s7, s43
    s_add_u32 s83, s7, s59
    s_mov_b32 m0, s83
    v_cmp_gt_i32 vcc, s81, v1
    s_mov_b64 exec, vcc
    buffer_load_dwordx4 v123, s[8:11], s82 offen lds
    v_cmp_gt_i32 vcc, s81, v103
    s_mov_b64 exec, vcc
    buffer_load_dwordx4 v123, s[8:11], s82 offen offset:1024 lds
    s_mov_b64 exec, -1
    s_add_u32 s79, s79, 64
    s_cmp_gt_i32 s78, 128
    s_cbranch_scc1 K2_LDX
    s_waitcnt vmcnt(0)
K2_LDD:
    s_waitcnt vmcnt(16)
    v_lshlrev_b32 v88, 16, v80
    v_mul_f32 v88, 0xbfb8aa3b, v88
    v_lshlrev_b32 v89, 16, v82
    v_mul_f32 v89, 0xbfb8aa3b, v89
    v_lshlrev_b32 v90, 16, v84
    v_mul_f32 v90, 0xbfb8aa3b, v90
    v_lshlrev_b32 v91, 16, v86
    v_mul_f32 v91, 0xbfb8aa3b, v91
    v_cvt_pk_bf16_f32 v16, v88, v89
    v_cvt_pk_bf16_f32 v17, v90, v91
    v_mov_b32 v18, 0xc1400000
    v_mov_b32 v19, 0
    v_and_b32 v88, 0xffff0000, v80
    v_mul_f32 v88, 0xbfb8aa3b, v88
    v_and_b32 v89, 0xffff0000, v82
    v_mul_f32 v89, 0xbfb8aa3b, v89
    v_and_b32 v90, 0xffff0000, v84
    v_mul_f32 v90, 0xbfb8aa3b, v90
    v_and_b32 v91, 0xffff0000, v86
    v_mul_f32 v91, 0xbfb8aa3b, v91
    v_cvt_pk_bf16_f32 v20, v88, v89
    v_cvt_pk_bf16_f32 v21, v90, v91
    v_mov_b32 v22, 0xc1400000
    v_mov_b32 v23, 0
    v_lshlrev_b32 v88, 16, v81
    v_mul_f32 v88, 0xbfb8aa3b, v88
    v_lshlrev_b32 v89, 16, v83
    v_mul_f32 v89, 0xbfb8aa3b, v89
    v_lshlrev_b32 v90, 16, v85
    v_mul_f32 v90, 0xbfb8aa3b, v90
    v_lshlrev_b32 v91, 16, v87
    v_mul_f32 v91, 0xbfb8aa3b, v91
    v_cvt_pk_bf16_f32 v24, v88, v89
    v_cvt_pk_bf16_f32 v25, v90, v91
    v_mov_b32 v26, 0xc1400000
    v_mov_b32 v27, 0
    v_and_b32 v88, 0xffff0000, v81
    v_mul_f32 v88, 0xbfb8aa3b, v88
    v_and_b32 v89, 0xffff0000, v83
    v_mul_f32 v89, 0xbfb8aa3b, v89
    v_and_b32 v90, 0xffff0000, v85
    v_mul_f32 v90, 0xbfb8aa3b, v90
    v_and_b32 v91, 0xffff0000, v87
    v_mul_f32 v91, 0xbfb8aa3b, v91
    v_cvt_pk_bf16_f32 v28, v88, v89
    v_cvt_pk_bf16_f32 v29, v90, v91
    v_mov_b32 v30, 0xc1400000
    v_mov_b32 v31, 0
    v_bfe_u32 v10, v1, 2, 2
    v_lshrrev_b32 v9, 4, v1
    v_cmp_eq_u32 vcc, v10, v9
    v_mov_b32 v10, 0x3f800000
    v_mov_b32 v11, 0x3f803f80
    v_cndmask_b32 v14, v10, v11, vcc
    v_mov_b32 v15, 0
    v_mov_b32 v6, 0x27800000
    v_mov_b32 v7, 0x27800000
K2_B3P:
    s_setprio 0
    s_waitcnt lgkmcnt(0) vmcnt(0)
K2_B3:
    s_barrier
    v_lshrrev_b32 v9, 4, v1
    s_mul_i32 s6, s5, 12
    v_mov_b32 v10, s6
    v_mov_b32 v110, 4608
    ds_read_b32 v108, v110
    ds_read_b32 v96, v10 offset:3584
    ds_read_b32 v97, v10 offset:2304
    ds_read_b32 v98, v10 offset:2308
    ds_read_b32 v99, v10 offset:2312
    v_lshlrev_b32 v11, 2, v9
    v_lshl_add_u32 v11, v10, 2, v11
    ds_read_b32 v116, v11 offset:3840
    ds_read_b32 v117, v11 offset:3856
    ds_read_b32 v126, v11 offset:3872
    s_waitcnt lgkmcnt(0)
    v_or_b32 v108, s26, v108
    v_cmp_ne_u32 vcc, 0, v108
    s_cbranch_vccnz K2_SLOW
    v_readfirstlane_b32 s61, v97
    v_readfirstlane_b32 s62, v98
    v_readfirstlane_b32 s63, v99
    v_lshlrev_b32 v96, 6, v96
    v_lshl_add_u32 v4, v9, 4, v96
    v_and_b32 v10, 15, v1
    v_lshl_add_u32 v3, v10, 2, v96
    ds_read_b128 v[8:11], v4 offset:5120
    ds_read_b32 v0, v3 offset:21504
    v_lshl_add_u32 v120, v116, 8, v2
    v_lshl_add_u32 v119, v116, 9, v127
    buffer_load_dwordx4 v[110:113], v120, s[12:15], 0 offen nt
    buffer_load_dwordx2 v[114:115], v119, s[16:19], 0 offen nt
    v_mov_b32 v116, v117
    v_mov_b32 v117, v126
    v_mov_b32 v126, 0x2710
    s_waitcnt lgkmcnt(0)
    v_add_u32 v8, v8, v2
    v_add_u32 v9, v9, v2
    v_add_u32 v10, v10, v2
    v_add_u32 v11, v11, v2
    buffer_load_dwordx4 v[32:35], v8, s[8:11], s24 offen
    buffer_load_dwordx4 v[36:39], v9, s[8:11], s24 offen
    buffer_load_dwordx4 v[40:43], v10, s[8:11], s24 offen
    buffer_load_dwordx4 v[44:47], v11, s[8:11], s24 offen
    ds_read_b128 v[8:11], v4 offset:5184
    v_add_u32 v0, v0, v118
    ds_read_b64 v[12:13], v0
    ds_read_b32 v0, v3 offset:21568
    s_mov_b32 s70, 0
    s_mov_b32 s67, 0
    s_waitcnt vmcnt(4)
    s_branch K2_NTSA
.p2align 6
    s_nop 0
    s_nop 0
    s_nop 0
    s_nop 0
    s_nop 0
    s_nop 0
    s_nop 0
    s_nop 0
K2_LOOPA:
    s_cmp_gt_i32 s60, 0
    s_cbranch_scc0 K2_NTA
K2_GOA:
    s_cmp_eq_u32 s60, 1
    s_cbranch_scc1 K2_HALFA
    s_waitcnt lgkmcnt(0)
    v_add_u32 v0, v0, v118
    v_add_u32 v8, v8, v2
    v_add_u32 v9, v9, v2
    v_add_u32 v10, v10, v2
    v_add_u32 v11, v11, v2
    buffer_load_dwordx4 v[48:51], v8, s[8:11], s24 offen
    buffer_load_dwordx4 v[52:55], v9, s[8:11], s24 offen
    buffer_load_dwordx4 v[56:59], v10, s[8:11], s24 offen
    buffer_load_dwordx4 v[60:63], v11, s[8:11], s24 offen
    ds_read_b128 v[8:11], v4 offset:5248
    s_cmp_lg_u32 s67, 0
    s_cbranch_scc1 K2_SW00
    s_waitcnt vmcnt(4)
K2_SW00:
    s_mov_b32 s67, 0
    v_lshlrev_b32 v64, 16, v32
    v_lshlrev_b32 v65, 16, v36
    v_lshlrev_b32 v66, 16, v40
    v_lshlrev_b32 v67, 16, v44
    v_lshlrev_b32 v68, 16, v33
    v_lshlrev_b32 v69, 16, v37
    v_lshlrev_b32 v70, 16, v41
    v_lshlrev_b32 v71, 16, v45
    v_mfma_f32_16x16x32_bf16 v[64:67], v[12:15], v[16:19], v[64:67]
    v_lshlrev_b32 v72, 16, v34
    v_lshlrev_b32 v73, 16, v38
    v_lshlrev_b32 v74, 16, v42
    v_lshlrev_b32 v75, 16, v46
    v_mfma_f32_16x16x32_bf16 v[68:71], v[12:15], v[20:23], v[68:71]
    v_lshlrev_b32 v76, 16, v35
    v_lshlrev_b32 v77, 16, v39
    v_lshlrev_b32 v78, 16, v43
    v_lshlrev_b32 v79, 16, v47
    v_mfma_f32_16x16x32_bf16 v[72:75], v[12:15], v[24:27], v[72:75]
    s_nop 0
    v_mfma_f32_16x16x32_bf16 v[76:79], v[12:15], v[28:31], v[76:79]
    ds_read_b64 v[12:13], v0
    ds_read_b32 v0, v3 offset:21632
    v_exp_f32_e64 v80, v64 clamp
    v_exp_f32_e64 v84, v65 clamp
    v_exp_f32_e64 v88, v66 clamp
    v_exp_f32_e64 v92, v67 clamp
    v_exp_f32_e64 v81, v68 clamp
    v_exp_f32_e64 v85, v69 clamp
    v_exp_f32_e64 v89, v70 clamp
    v_exp_f32_e64 v93, v71 clamp
    v_exp_f32_e64 v82, v72 clamp
    v_exp_f32_e64 v86, v73 clamp
    v_exp_f32_e64 v90, v74 clamp
    v_exp_f32_e64 v94, v75 clamp
    v_exp_f32_e64 v83, v76 clamp
    v_exp_f32_e64 v87, v77 clamp
    v_exp_f32_e64 v91, v78 clamp
    v_exp_f32_e64 v95, v79 clamp
    v_pk_add_f32 v[80:81], v[80:81], v[6:7]
    v_pk_add_f32 v[82:83], v[82:83], v[6:7]
    v_pk_add_f32 v[84:85], v[84:85], v[6:7]
    v_pk_add_f32 v[86:87], v[86:87], v[6:7]
    v_pk_add_f32 v[88:89], v[88:89], v[6:7]
    v_pk_add_f32 v[90:91], v[90:91], v[6:7]
    v_pk_add_f32 v[92:93], v[92:93], v[6:7]
    v_pk_add_f32 v[94:95], v[94:95], v[6:7]
    v_pk_mul_f32 v[64:65], v[80:81], v[84:85]
    v_pk_mul_f32 v[66:67], v[32:33], v[84:85]
    v_rcp_f32 v64, v64
    v_rcp_f32 v65, v65
    v_pk_fma_f32 v[66:67], v[36:37], v[80:81], v[66:67]
    v_pk_add_f32 v[68:69], v[80:81], v[84:85]
    v_pk_fma_f32 v[96:97], v[66:67], v[64:65], v[96:97]
    v_pk_fma_f32 v[100:101], v[68:69], v[64:65], v[100:101]
    v_pk_mul_f32 v[70:71], v[82:83], v[86:87]
    v_pk_mul_f32 v[72:73], v[34:35], v[86:87]
    v_rcp_f32 v70, v70
    v_rcp_f32 v71, v71
    v_pk_fma_f32 v[72:73], v[38:39], v[82:83], v[72:73]
    v_pk_add_f32 v[74:75], v[82:83], v[86:87]
    v_pk_fma_f32 v[98:99], v[72:73], v[70:71], v[98:99]
    v_pk_fma_f32 v[102:103], v[74:75], v[70:71], v[102:103]
    v_pk_mul_f32 v[64:65], v[88:89], v[92:93]
    v_pk_mul_f32 v[66:67], v[40:41], v[92:93]
    v_rcp_f32 v64, v64
    v_rcp_f32 v65, v65
    v_pk_fma_f32 v[66:67], v[44:45], v[88:89], v[66:67]
    v_pk_add_f32 v[68:69], v[88:89], v[92:93]
    v_pk_fma_f32 v[96:97], v[66:67], v[64:65], v[96:97]
    v_pk_fma_f32 v[100:101], v[68:69], v[64:65], v[100:101]
    v_pk_mul_f32 v[70:71], v[90:91], v[94:95]
    v_pk_mul_f32 v[72:73], v[42:43], v[94:95]
    v_rcp_f32 v70, v70
    v_rcp_f32 v71, v71
    v_pk_fma_f32 v[72:73], v[46:47], v[90:91], v[72:73]
    v_pk_add_f32 v[74:75], v[90:91], v[94:95]
    v_pk_fma_f32 v[98:99], v[72:73], v[70:71], v[98:99]
    v_pk_fma_f32 v[102:103], v[74:75], v[70:71], v[102:103]
K2_AFTA:
    s_sub_i32 s60, s60, 2
K2_LOOPB:
    s_cmp_gt_i32 s60, 0
    s_cbranch_scc0 K2_NTB
K2_GOB:
    s_cmp_eq_u32 s60, 1
    s_cbranch_scc1 K2_HALFB
    s_waitcnt lgkmcnt(0)
    v_add_u32 v0, v0, v118
    v_add_u32 v8, v8, v2
    v_add_u32 v9, v9, v2
    v_add_u32 v10, v10, v2
    v_add_u32 v11, v11, v2
    buffer_load_dwordx4 v[32:35], v8, s[8:11], s24 offen
    buffer_load_dwordx4 v[36:39], v9, s[8:11], s24 offen
    buffer_load_dwordx4 v[40:43], v10, s[8:11], s24 offen
    buffer_load_dwordx4 v[44:47], v11, s[8:11], s24 offen
    ds_read_b128 v[8:11], v4 offset:5312
    s_cmp_lg_u32 s67, 0
    s_cbranch_scc1 K2_SW10
    s_waitcnt vmcnt(4)
K2_SW10:
    s_mov_b32 s67, 0
    v_lshlrev_b32 v64, 16, v48
    v_lshlrev_b32 v65, 16, v52
    v_lshlrev_b32 v66, 16, v56
    v_lshlrev_b32 v67, 16, v60
    v_lshlrev_b32 v68, 16, v49
    v_lshlrev_b32 v69, 16, v53
    v_lshlrev_b32 v70, 16, v57
    v_lshlrev_b32 v71, 16, v61
    v_mfma_f32_16x16x32_bf16 v[64:67], v[12:15], v[16:19], v[64:67]
    v_lshlrev_b32 v72, 16, v50
    v_lshlrev_b32 v73, 16, v54
    v_lshlrev_b32 v74, 16, v58
    v_lshlrev_b32 v75, 16, v62
    v_mfma_f32_16x16x32_bf16 v[68:71], v[12:15], v[20:23], v[68:71]
    v_lshlrev_b32 v76, 16, v51
    v_lshlrev_b32 v77, 16, v55
    v_lshlrev_b32 v78, 16, v59
    v_lshlrev_b32 v79, 16, v63
    v_mfma_f32_16x16x32_bf16 v[72:75], v[12:15], v[24:27], v[72:75]
    s_nop 0
    v_mfma_f32_16x16x32_bf16 v[76:79], v[12:15], v[28:31], v[76:79]
    ds_read_b64 v[12:13], v0
    ds_read_b32 v0, v3 offset:21696
    v_exp_f32_e64 v80, v64 clamp
    v_exp_f32_e64 v84, v65 clamp
    v_exp_f32_e64 v88, v66 clamp
    v_exp_f32_e64 v92, v67 clamp
    v_exp_f32_e64 v81, v68 clamp
    v_exp_f32_e64 v85, v69 clamp
    v_exp_f32_e64 v89, v70 clamp
    v_exp_f32_e64 v93, v71 clamp
    v_exp_f32_e64 v82, v72 clamp
    v_exp_f32_e64 v86, v73 clamp
    v_exp_f32_e64 v90, v74 clamp
    v_exp_f32_e64 v94, v75 clamp
    v_exp_f32_e64 v83, v76 clamp
    v_exp_f32_e64 v87, v77 clamp
    v_exp_f32_e64 v91, v78 clamp
    v_exp_f32_e64 v95, v79 clamp
    v_pk_add_f32 v[80:81], v[80:81], v[6:7]
    v_pk_add_f32 v[82:83], v[82:83], v[6:7]
    v_pk_add_f32 v[84:85], v[84:85], v[6:7]
    v_pk_add_f32 v[86:87], v[86:87], v[6:7]
    v_pk_add_f32 v[88:89], v[88:89], v[6:7]
    v_pk_add_f32 v[90:91], v[90:91], v[6:7]
    v_pk_add_f32 v[92:93], v[92:93], v[6:7]
    v_pk_add_f32 v[94:95], v[94:95], v[6:7]
    v_pk_mul_f32 v[64:65], v[80:81], v[84:85]
    v_pk_mul_f32 v[66:67], v[48:49], v[84:85]
    v_rcp_f32 v64, v64
    v_rcp_f32 v65, v65
    v_pk_fma_f32 v[66:67], v[52:53], v[80:81], v[66:67]
    v_pk_add_f32 v[68:69], v[80:81], v[84:85]
    v_pk_fma_f32 v[96:97], v[66:67], v[64:65], v[96:97]
    v_pk_fma_f32 v[100:101], v[68:69], v[64:65], v[100:101]
    v_pk_mul_f32 v[70:71], v[82:83], v[86:87]
    v_pk_mul_f32 v[72:73], v[50:51], v[86:87]
    v_rcp_f32 v70, v70
    v_rcp_f32 v71, v71
    v_pk_fma_f32 v[72:73], v[54:55], v[82:83], v[72:73]
    v_pk_add_f32 v[74:75], v[82:83], v[86:87]
    v_pk_fma_f32 v[98:99], v[72:73], v[70:71], v[98:99]
    v_pk_fma_f32 v[102:103], v[74:75], v[70:71], v[102:103]
    v_pk_mul_f32 v[64:65], v[88:89], v[92:93]
    v_pk_mul_f32 v[66:67], v[56:57], v[92:93]
    v_rcp_f32 v64, v64
    v_rcp_f32 v65, v65
    v_pk_fma_f32 v[66:67], v[60:61], v[88:89], v[66:67]
    v_pk_add_f32 v[68:69], v[88:89], v[92:93]
    v_pk_fma_f32 v[96:97], v[66:67], v[64:65], v[96:97]
    v_pk_fma_f32 v[100:101], v[68:69], v[64:65], v[100:101]
    v_pk_mul_f32 v[70:71], v[90:91], v[94:95]
    v_pk_mul_f32 v[72:73], v[58:59], v[94:95]
    v_rcp_f32 v70, v70
    v_rcp_f32 v71, v71
    v_pk_fma_f32 v[72:73], v[62:63], v[90:91], v[72:73]
    v_pk_add_f32 v[74:75], v[90:91], v[94:95]
    v_pk_fma_f32 v[98:99], v[72:73], v[70:71], v[98:99]
    v_pk_fma_f32 v[102:103], v[74:75], v[70:71], v[102:103]
    v_add_u32 v4, 128, v4
    v_add_u32 v3, 128, v3
K2_AFTB:
    s_sub_i32 s60, s60, 2
    s_branch K2_LOOPA
K2_HALFA:
    s_waitcnt lgkmcnt(0)
    v_add_u32 v0, v0, v118
    v_add_u32 v8, v8, v2
    v_add_u32 v9, v9, v2
    v_add_u32 v10, v10, v2
    v_add_u32 v11, v11, v2
    buffer_load_dwordx4 v[48:51], v8, s[8:11], s24 offen
    buffer_load_dwordx4 v[52:55], v9, s[8:11], s24 offen
    buffer_load_dwordx4 v[56:59], v10, s[8:11], s24 offen
    buffer_load_dwordx4 v[60:63], v11, s[8:11], s24 offen
    ds_read_b128 v[8:11], v4 offset:5248
    s_cmp_lg_u32 s67, 0
    s_cbranch_scc1 K2_SW01
    s_waitcnt vmcnt(4)
K2_SW01:
    s_mov_b32 s67, 0
    v_lshlrev_b32 v64, 16, v32
    v_lshlrev_b32 v65, 16, v36
    v_lshlrev_b32 v68, 16, v33
    v_lshlrev_b32 v69, 16, v37
    v_mfma_f32_16x16x32_bf16 v[64:67], v[12:15], v[16:19], v[64:67]
    v_lshlrev_b32 v72, 16, v34
    v_lshlrev_b32 v73, 16, v38
    v_mfma_f32_16x16x32_bf16 v[68:71], v[12:15], v[20:23], v[68:71]
    v_lshlrev_b32 v76, 16, v35
    v_lshlrev_b32 v77, 16, v39
    v_mfma_f32_16x16x32_bf16 v[72:75], v[12:15], v[24:27], v[72:75]
    s_nop 0
    v_mfma_f32_16x16x32_bf16 v[76:79], v[12:15], v[28:31], v[76:79]
    ds_read_b64 v[12:13], v0
    ds_read_b32 v0, v3 offset:21632
    s_nop 0
    v_exp_f32_e64 v80, v64 clamp
    v_exp_f32_e64 v84, v65 clamp
    v_exp_f32_e64 v81, v68 clamp
    v_exp_f32_e64 v85, v69 clamp
    v_exp_f32_e64 v82, v72 clamp
    v_exp_f32_e64 v86, v73 clamp
    v_exp_f32_e64 v83, v76 clamp
    v_exp_f32_e64 v87, v77 clamp
    v_pk_add_f32 v[80:81], v[80:81], v[6:7]
    v_pk_add_f32 v[82:83], v[82:83], v[6:7]
    v_pk_add_f32 v[84:85], v[84:85], v[6:7]
    v_pk_add_f32 v[86:87], v[86:87], v[6:7]
    v_pk_mul_f32 v[64:65], v[80:81], v[84:85]
    v_pk_mul_f32 v[66:67], v[32:33], v[84:85]
    v_rcp_f32 v64, v64
    v_rcp_f32 v65, v65
    v_pk_fma_f32 v[66:67], v[36:37], v[80:81], v[66:67]
    v_pk_add_f32 v[68:69], v[80:81], v[84:85]
    v_pk_fma_f32 v[96:97], v[66:67], v[64:65], v[96:97]
    v_pk_fma_f32 v[100:101], v[68:69], v[64:65], v[100:101]
    v_pk_mul_f32 v[70:71], v[82:83], v[86:87]
    v_pk_mul_f32 v[72:73], v[34:35], v[86:87]
    v_rcp_f32 v70, v70
    v_rcp_f32 v71, v71
    v_pk_fma_f32 v[72:73], v[38:39], v[82:83], v[72:73]
    v_pk_add_f32 v[74:75], v[82:83], v[86:87]
    v_pk_fma_f32 v[98:99], v[72:73], v[70:71], v[98:99]
    v_pk_fma_f32 v[102:103], v[74:75], v[70:71], v[102:103]
    s_branch K2_AFTA
K2_NTA:
    s_waitcnt vmcnt(0)
    s_mov_b32 s70, 1
    v_rcp_f32 v120, v100
    v_rcp_f32 v121, v101
    v_rcp_f32 v122, v102
    v_rcp_f32 v123, v103
    v_and_b32 v104, 0xffff0000, v104
    v_and_b32 v105, 0xffff0000, v105
    v_and_b32 v106, 0xffff0000, v106
    v_and_b32 v107, 0xffff0000, v107
    v_fma_f32 v96, v96, v120, v104
    v_fma_f32 v97, v97, v121, v105
    v_fma_f32 v98, v98, v122, v106
    v_fma_f32 v99, v99, v123, v107
    v_lshlrev_b32 v120, 16, v108
    v_and_b32 v121, 0xffff0000, v108
    v_lshlrev_b32 v122, 16, v109
    v_and_b32 v123, 0xffff0000, v109
    v_max_f32 v96, 0, v96
    v_max_f32 v97, 0, v97
    v_max_f32 v98, 0, v98
    v_max_f32 v99, 0, v99
    v_add_f32 v96, v96, v120
    v_add_f32 v97, v97, v121
    v_add_f32 v98, v98, v122
    v_add_f32 v99, v99, v123
    v_cvt_pk_bf16_f32 v120, v96, v97
    v_cvt_pk_bf16_f32 v121, v98, v99
    s_nop 1
    v_mov_b32_dpp v122, v120 quad_perm:[1,1,3,3] row_mask:0xf bank_mask:0xf
    v_mov_b32_dpp v123, v121 quad_perm:[1,1,3,3] row_mask:0xf bank_mask:0xf
    s_mov_b64 exec, s[68:69]
    buffer_store_dwordx4 v[120:123], v5, s[20:23], 0 offen sc1
    s_mov_b64 exec, -1
    s_nop 0
K2_NTSA:
    s_cmp_eq_u32 s64, 0
    s_cbranch_scc1 K2_END
    s_sub_u32 s64, s64, 1
    v_mov_b32 v104, v110
    v_mov_b32 v105, v111
    v_mov_b32 v106, v112
    v_mov_b32 v107, v113
    v_mov_b32 v108, v114
    v_mov_b32 v109, v115
    v_mov_b32 v5, v119
    v_bfi_b32 v18, s65, v104, v18
    v_bfi_b32 v22, s65, v105, v22
    v_bfi_b32 v26, s65, v106, v26
    v_bfi_b32 v30, s65, v107, v30
    v_mov_b32 v96, 0
    v_mov_b32 v97, 0
    v_mov_b32 v98, 0
    v_mov_b32 v99, 0
    v_mov_b32 v100, 0x4d8637bd
    v_mov_b32 v101, 0x4d8637bd
    v_mov_b32 v102, 0x4d8637bd
    v_mov_b32 v103, 0x4d8637bd
    v_lshl_add_u32 v120, v116, 8, v2
    v_lshl_add_u32 v119, v116, 9, v127
    buffer_load_dwordx4 v[110:113], v120, s[12:15], 0 offen nt
    buffer_load_dwordx2 v[114:115], v119, s[16:19], 0 offen nt
    v_mov_b32 v116, v117
    v_mov_b32 v117, v126
    v_mov_b32 v126, 0x2710
    s_cmp_eq_u32 s64, 0
    s_cbranch_scc1 K2_PR0A
    s_cmp_eq_u32 s64, 1
    s_cbranch_scc1 K2_PR1A
    s_setprio 2
    s_branch K2_PRDA
K2_PR1A:
    s_setprio 1
    s_branch K2_PRDA
K2_PR0A:
    s_setprio 0
K2_PRDA:
    s_mov_b32 s67, s70
    s_mov_b32 s60, s61
    s_mov_b32 s61, s62
    s_mov_b32 s62, s63
    s_cmp_le_i32 s60, 0
    s_cbranch_scc1 K2_NTA
    s_branch K2_GOA
K2_HALFB:
    s_waitcnt lgkmcnt(0)
    v_add_u32 v0, v0, v118
    v_add_u32 v8, v8, v2
    v_add_u32 v9, v9, v2
    v_add_u32 v10, v10, v2
    v_add_u32 v11, v11, v2
    buffer_load_dwordx4 v[32:35], v8, s[8:11], s24 offen
    buffer_load_dwordx4 v[36:39], v9, s[8:11], s24 offen
    buffer_load_dwordx4 v[40:43], v10, s[8:11], s24 offen
    buffer_load_dwordx4 v[44:47], v11, s[8:11], s24 offen
    ds_read_b128 v[8:11], v4 offset:5312
    s_cmp_lg_u32 s67, 0
    s_cbranch_scc1 K2_SW11
    s_waitcnt vmcnt(4)
K2_SW11:
    s_mov_b32 s67, 0
    v_lshlrev_b32 v64, 16, v48
    v_lshlrev_b32 v65, 16, v52
    v_lshlrev_b32 v68, 16, v49
    v_lshlrev_b32 v69, 16, v53
    v_mfma_f32_16x16x32_bf16 v[64:67], v[12:15], v[16:19], v[64:67]
    v_lshlrev_b32 v72, 16, v50
    v_lshlrev_b32 v73, 16, v54
    v_mfma_f32_16x16x32_bf16 v[68:71], v[12:15], v[20:23], v[68:71]
    v_lshlrev_b32 v76, 16, v51
    v_lshlrev_b32 v77, 16, v55
    v_mfma_f32_16x16x32_bf16 v[72:75], v[12:15], v[24:27], v[72:75]
    s_nop 0
    v_mfma_f32_16x16x32_bf16 v[76:79], v[12:15], v[28:31], v[76:79]
    ds_read_b64 v[12:13], v0
    ds_read_b32 v0, v3 offset:21696
    s_nop 0
    v_exp_f32_e64 v80, v64 clamp
    v_exp_f32_e64 v84, v65 clamp
    v_exp_f32_e64 v81, v68 clamp
    v_exp_f32_e64 v85, v69 clamp
    v_exp_f32_e64 v82, v72 clamp
    v_exp_f32_e64 v86, v73 clamp
    v_exp_f32_e64 v83, v76 clamp
    v_exp_f32_e64 v87, v77 clamp
    v_pk_add_f32 v[80:81], v[80:81], v[6:7]
    v_pk_add_f32 v[82:83], v[82:83], v[6:7]
    v_pk_add_f32 v[84:85], v[84:85], v[6:7]
    v_pk_add_f32 v[86:87], v[86:87], v[6:7]
    v_pk_mul_f32 v[64:65], v[80:81], v[84:85]
    v_pk_mul_f32 v[66:67], v[48:49], v[84:85]
    v_rcp_f32 v64, v64
    v_rcp_f32 v65, v65
    v_pk_fma_f32 v[66:67], v[52:53], v[80:81], v[66:67]
    v_pk_add_f32 v[68:69], v[80:81], v[84:85]
    v_pk_fma_f32 v[96:97], v[66:67], v[64:65], v[96:97]
    v_pk_fma_f32 v[100:101], v[68:69], v[64:65], v[100:101]
    v_pk_mul_f32 v[70:71], v[82:83], v[86:87]
    v_pk_mul_f32 v[72:73], v[50:51], v[86:87]
    v_rcp_f32 v70, v70
    v_rcp_f32 v71, v71
    v_pk_fma_f32 v[72:73], v[54:55], v[82:83], v[72:73]
    v_pk_add_f32 v[74:75], v[82:83], v[86:87]
    v_pk_fma_f32 v[98:99], v[72:73], v[70:71], v[98:99]
    v_pk_fma_f32 v[102:103], v[74:75], v[70:71], v[102:103]
    v_add_u32 v4, 128, v4
    v_add_u32 v3, 128, v3
    s_branch K2_AFTB
K2_NTB:
    s_waitcnt vmcnt(0)
    s_mov_b32 s70, 1
    v_rcp_f32 v120, v100
    v_rcp_f32 v121, v101
    v_rcp_f32 v122, v102
    v_rcp_f32 v123, v103
    v_and_b32 v104, 0xffff0000, v104
    v_and_b32 v105, 0xffff0000, v105
    v_and_b32 v106, 0xffff0000, v106
    v_and_b32 v107, 0xffff0000, v107
    v_fma_f32 v96, v96, v120, v104
    v_fma_f32 v97, v97, v121, v105
    v_fma_f32 v98, v98, v122, v106
    v_fma_f32 v99, v99, v123, v107
    v_lshlrev_b32 v120, 16, v108
    v_and_b32 v121, 0xffff0000, v108
    v_lshlrev_b32 v122, 16, v109
    v_and_b32 v123, 0xffff0000, v109
    v_max_f32 v96, 0, v96
    v_max_f32 v97, 0, v97
    v_max_f32 v98, 0, v98
    v_max_f32 v99, 0, v99
    v_add_f32 v96, v96, v120
    v_add_f32 v97, v97, v121
    v_add_f32 v98, v98, v122
    v_add_f32 v99, v99, v123
    v_cvt_pk_bf16_f32 v120, v96, v97
    v_cvt_pk_bf16_f32 v121, v98, v99
    s_nop 1
    v_mov_b32_dpp v122, v120 quad_perm:[1,1,3,3] row_mask:0xf bank_mask:0xf
    v_mov_b32_dpp v123, v121 quad_perm:[1,1,3,3] row_mask:0xf bank_mask:0xf
    s_mov_b64 exec, s[68:69]
    buffer_store_dwordx4 v[120:123], v5, s[20:23], 0 offen sc1
    s_mov_b64 exec, -1
    s_nop 0
K2_NTSB:
    s_cmp_eq_u32 s64, 0
    s_cbranch_scc1 K2_END
    s_sub_u32 s64, s64, 1
    v_mov_b32 v104, v110
    v_mov_b32 v105, v111
    v_mov_b32 v106, v112
    v_mov_b32 v107, v113
    v_mov_b32 v108, v114
    v_mov_b32 v109, v115
    v_mov_b32 v5, v119
    v_bfi_b32 v18, s65, v104, v18
    v_bfi_b32 v22, s65, v105, v22
    v_bfi_b32 v26, s65, v106, v26
    v_bfi_b32 v30, s65, v107, v30
    v_mov_b32 v96, 0
    v_mov_b32 v97, 0
    v_mov_b32 v98, 0
    v_mov_b32 v99, 0
    v_mov_b32 v100, 0x4d8637bd
    v_mov_b32 v101, 0x4d8637bd
    v_mov_b32 v102, 0x4d8637bd
    v_mov_b32 v103, 0x4d8637bd
    v_lshl_add_u32 v120, v116, 8, v2
    v_lshl_add_u32 v119, v116, 9, v127
    buffer_load_dwordx4 v[110:113], v120, s[12:15], 0 offen nt
    buffer_load_dwordx2 v[114:115], v119, s[16:19], 0 offen nt
    v_mov_b32 v116, v117
    v_mov_b32 v117, v126
    v_mov_b32 v126, 0x2710
    s_cmp_eq_u32 s64, 0
    s_cbranch_scc1 K2_PR0B
    s_cmp_eq_u32 s64, 1
    s_cbranch_scc1 K2_PR1B
    s_setprio 2
    s_branch K2_PRDB
K2_PR1B:
    s_setprio 1
    s_branch K2_PRDB
K2_PR0B:
    s_setprio 0
K2_PRDB:
    s_mov_b32 s67, s70
    s_mov_b32 s60, s61
    s_mov_b32 s61, s62
    s_mov_b32 s62, s63
    s_cmp_le_i32 s60, 0
    s_cbranch_scc1 K2_NTB
    s_branch K2_GOB
K2_SLOW:
    s_setprio 0
    s_barrier
    v_mbcnt_lo_u32_b32 v1, -1, 0
    v_mbcnt_hi_u32_b32 v1, -1, v1
    s_lshl_b32 s6, s5, 6
    v_add_u32 v2, s6, v1
    v_lshlrev_b32 v3, 4, v2
    v_mov_b32 v4, 0
    v_mov_b32 v5, 0
    v_mov_b32 v6, 0
    v_mov_b32 v7, 0
    v_add_u32 v8, 0, v3
    ds_write_b128 v8, v[4:7]
    v_add_u32 v8, 16384, v3
    ds_write_b128 v8, v[4:7]
    v_add_u32 v8, 32768, v3
    ds_write_b128 v8, v[4:7]
    v_add_u32 v8, 49152, v3
    ds_write_b128 v8, v[4:7]
    v_add_u32 v8, 65536, v3
    ds_write_b128 v8, v[4:7]
    v_add_u32 v8, 81920, v3
    ds_write_b128 v8, v[4:7]
    s_lshl_b32 s6, s3, 7
    v_lshlrev_b32 v9, 1, v1
    v_add_u32 v9, s6, v9
    buffer_load_ushort v32, v9, s[32:35], 0 offen offset:0
    s_mov_b32 s70, 512
    buffer_load_ushort v33, v9, s[32:35], s70 offen
    s_mov_b32 s70, 1024
    buffer_load_ushort v34, v9, s[32:35], s70 offen
    s_mov_b32 s70, 1536
    buffer_load_ushort v35, v9, s[32:35], s70 offen
    s_mov_b32 s70, 2048
    buffer_load_ushort v36, v9, s[32:35], s70 offen
    s_mov_b32 s70, 2560
    buffer_load_ushort v37, v9, s[32:35], s70 offen
    s_mov_b32 s70, 3072
    buffer_load_ushort v38, v9, s[32:35], s70 offen
    s_mov_b32 s70, 3584
    buffer_load_ushort v39, v9, s[32:35], s70 offen
    s_mov_b32 s70, 4096
    buffer_load_ushort v40, v9, s[32:35], s70 offen
    s_mov_b32 s70, 4608
    buffer_load_ushort v41, v9, s[32:35], s70 offen
    s_mov_b32 s70, 5120
    buffer_load_ushort v42, v9, s[32:35], s70 offen
    s_mov_b32 s70, 5632
    buffer_load_ushort v43, v9, s[32:35], s70 offen
    s_mov_b32 s70, 6144
    buffer_load_ushort v44, v9, s[32:35], s70 offen
    s_mov_b32 s70, 6656
    buffer_load_ushort v45, v9, s[32:35], s70 offen
    s_mov_b32 s70, 7168
    buffer_load_ushort v46, v9, s[32:35], s70 offen
    s_mov_b32 s70, 7680
    buffer_load_ushort v47, v9, s[32:35], s70 offen
    s_mov_b32 s70, 8192
    v_lshlrev_b32 v10, 2, v1
    s_waitcnt vmcnt(0)
    v_lshlrev_b32 v32, 16, v32
    v_mul_f32 v32, 0xbfb8aa3b, v32
    v_cvt_pk_bf16_f32 v32, v32, 0
    v_lshlrev_b32 v32, 16, v32
    v_lshlrev_b32 v33, 16, v33
    v_mul_f32 v33, 0xbfb8aa3b, v33
    v_cvt_pk_bf16_f32 v33, v33, 0
    v_lshlrev_b32 v33, 16, v33
    v_lshlrev_b32 v34, 16, v34
    v_mul_f32 v34, 0xbfb8aa3b, v34
    v_cvt_pk_bf16_f32 v34, v34, 0
    v_lshlrev_b32 v34, 16, v34
    v_lshlrev_b32 v35, 16, v35
    v_mul_f32 v35, 0xbfb8aa3b, v35
    v_cvt_pk_bf16_f32 v35, v35, 0
    v_lshlrev_b32 v35, 16, v35
    v_lshlrev_b32 v36, 16, v36
    v_mul_f32 v36, 0xbfb8aa3b, v36
    v_cvt_pk_bf16_f32 v36, v36, 0
    v_lshlrev_b32 v36, 16, v36
    v_lshlrev_b32 v37, 16, v37
    v_mul_f32 v37, 0xbfb8aa3b, v37
    v_cvt_pk_bf16_f32 v37, v37, 0
    v_lshlrev_b32 v37, 16, v37
    v_lshlrev_b32 v38, 16, v38
    v_mul_f32 v38, 0xbfb8aa3b, v38
    v_cvt_pk_bf16_f32 v38, v38, 0
    v_lshlrev_b32 v38, 16, v38
    v_lshlrev_b32 v39, 16, v39
    v_mul_f32 v39, 0xbfb8aa3b, v39
    v_cvt_pk_bf16_f32 v39, v39, 0
    v_lshlrev_b32 v39, 16, v39
    v_lshlrev_b32 v40, 16, v40
    v_mul_f32 v40, 0xbfb8aa3b, v40
    v_cvt_pk_bf16_f32 v40, v40, 0
    v_lshlrev_b32 v40, 16, v40
    v_lshlrev_b32 v41, 16, v41
    v_mul_f32 v41, 0xbfb8aa3b, v41
    v_cvt_pk_bf16_f32 v41, v41, 0
    v_lshlrev_b32 v41, 16, v41
    v_lshlrev_b32 v42, 16, v42
    v_mul_f32 v42, 0xbfb8aa3b, v42
    v_cvt_pk_bf16_f32 v42, v42, 0
    v_lshlrev_b32 v42, 16, v42
    v_lshlrev_b32 v43, 16, v43
    v_mul_f32 v43, 0xbfb8aa3b, v43
    v_cvt_pk_bf16_f32 v43, v43, 0
    v_lshlrev_b32 v43, 16, v43
    v_lshlrev_b32 v44, 16, v44
    v_mul_f32 v44, 0xbfb8aa3b, v44
    v_cvt_pk_bf16_f32 v44, v44, 0
    v_lshlrev_b32 v44, 16, v44
    v_lshlrev_b32 v45, 16, v45
    v_mul_f32 v45, 0xbfb8aa3b, v45
    v_cvt_pk_bf16_f32 v45, v45, 0
    v_lshlrev_b32 v45, 16, v45
    v_lshlrev_b32 v46, 16, v46
    v_mul_f32 v46, 0xbfb8aa3b, v46
    v_cvt_pk_bf16_f32 v46, v46, 0
    v_lshlrev_b32 v46, 16, v46
    v_lshlrev_b32 v47, 16, v47
    v_mul_f32 v47, 0xbfb8aa3b, v47
    v_cvt_pk_bf16_f32 v47, v47, 0
    v_lshlrev_b32 v47, 16, v47
    s_waitcnt lgkmcnt(0)
    s_barrier
    s_lshl_b32 s70, s5, 2
    s_add_u32 s71, s70, 4
K2S_CH:
    s_lshl_b32 s6, s4, 6
    s_add_u32 s6, s6, s70
    s_lshl_b32 s6, s6, 2
    s_add_u32 s6, s6, 26241024
    s_buffer_load_dword s72, s[8:11], s6
    s_waitcnt lgkmcnt(0)
    s_and_b32 s73, s72, 0xffff
    s_lshr_b32 s72, s72, 16
    s_mul_i32 s6, s70, 2500
    s_add_u32 s73, s73, s6
K2S_ED:
    s_cmp_eq_u32 s72, 0
    s_cbranch_scc1 K2S_CHD
    s_lshl_b32 s6, s73, 2
    s_add_u32 s6, s6, 20481024
    s_buffer_load_dword s74, s[8:11], s6
    s_lshl_b32 s6, s73, 5
    s_add_u32 s6, s6, 21121024
    s_buffer_load_dwordx8 s[76:83], s[8:11], s6
    s_waitcnt lgkmcnt(0)
    s_and_b32 s75, s74, 0xff
    s_and_b32 s74, s74, 0xffffff00
    s_add_u32 s74, s74, s24
    buffer_load_dword v11, v10, s[8:11], s74 offen
    s_mul_i32 s6, s4, 157
    s_add_u32 s6, s6, s75
    s_lshl_b32 s6, s6, 8
    buffer_load_dword v12, v10, s[12:15], s6 offen
    v_mov_b32 v13, 0
    s_lshl_b32 s6, s76, 16
    v_fmac_f32 v13, s6, v32
    s_and_b32 s6, s76, 0xffff0000
    v_fmac_f32 v13, s6, v33
    s_lshl_b32 s6, s77, 16
    v_fmac_f32 v13, s6, v34
    s_and_b32 s6, s77, 0xffff0000
    v_fmac_f32 v13, s6, v35
    s_lshl_b32 s6, s78, 16
    v_fmac_f32 v13, s6, v36
    s_and_b32 s6, s78, 0xffff0000
    v_fmac_f32 v13, s6, v37
    s_lshl_b32 s6, s79, 16
    v_fmac_f32 v13, s6, v38
    s_and_b32 s6, s79, 0xffff0000
    v_fmac_f32 v13, s6, v39
    s_lshl_b32 s6, s80, 16
    v_fmac_f32 v13, s6, v40
    s_and_b32 s6, s80, 0xffff0000
    v_fmac_f32 v13, s6, v41
    s_lshl_b32 s6, s81, 16
    v_fmac_f32 v13, s6, v42
    s_and_b32 s6, s81, 0xffff0000
    v_fmac_f32 v13, s6, v43
    s_lshl_b32 s6, s82, 16
    v_fmac_f32 v13, s6, v44
    s_and_b32 s6, s82, 0xffff0000
    v_fmac_f32 v13, s6, v45
    s_lshl_b32 s6, s83, 16
    v_fmac_f32 v13, s6, v46
    s_and_b32 s6, s83, 0xffff0000
    v_fmac_f32 v13, s6, v47
    s_waitcnt vmcnt(0)
    v_lshlrev_b32 v14, 16, v11
    v_lshlrev_b32 v15, 16, v12
    v_add_f32 v13, v13, v14
    v_add_f32 v13, v13, v15
    v_add_f32 v13, 0xc2400000, v13
    v_exp_f32_e64 v13, v13 clamp
    s_nop 0
    v_add_f32 v13, 0x27800000, v13
    v_rcp_f32 v13, v13
    s_lshl_b32 s6, s75, 8
    v_add_u32 v16, s6, v10
    v_mul_f32 v14, v13, v11
    ds_add_f32 v16, v14 offset:0
    ds_add_f32 v16, v13 offset:49152
    s_add_u32 s73, s73, 1
    s_sub_u32 s72, s72, 1
    s_branch K2S_ED
K2S_CHD:
    s_add_u32 s70, s70, 1
    s_cmp_lt_u32 s70, s71
    s_cbranch_scc1 K2S_CH
    s_waitcnt lgkmcnt(0)
    s_barrier
    s_mul_i32 s72, s4, 157
    s_sub_u32 s73, 10000, s72
    s_min_u32 s73, s73, 157
    s_mov_b32 s70, s5
K2S_FN:
    s_cmp_ge_u32 s70, s73
    s_cbranch_scc1 K2_END2
    s_lshl_b32 s6, s70, 8
    v_add_u32 v16, s6, v10
    ds_read_b32 v13, v16 offset:0
    ds_read_b32 v14, v16 offset:49152
    s_add_u32 s74, s72, s70
    s_lshl_b32 s6, s74, 8
    buffer_load_dword v12, v10, s[12:15], s6 offen
    s_lshl_b32 s6, s74, 9
    buffer_load_ushort v11, v9, s[16:19], s6 offen
    s_waitcnt vmcnt(0) lgkmcnt(0)
    v_add_f32 v14, 0x4d8637bd, v14
    v_rcp_f32 v14, v14
    v_and_b32 v12, 0xffff0000, v12
    v_lshlrev_b32 v11, 16, v11
    v_fma_f32 v13, v13, v14, v12
    v_max_f32 v13, 0, v13
    v_add_f32 v13, v13, v11
    v_cvt_pk_bf16_f32 v13, v13, 0
    buffer_store_short v13, v9, s[20:23], s6 offen
    s_add_u32 s70, s70, 16
    s_branch K2S_FN
K2_END:
K2_END2:
    s_endpgm
K2_CODE_END:
.section .rodata,"a"
.p2align 6
.amdhsa_kernel k1_kernel
  .amdhsa_next_free_vgpr 256
  .amdhsa_next_free_sgpr 102
  .amdhsa_accum_offset 256
  .amdhsa_group_segment_fixed_size 0
  .amdhsa_kernarg_size 96
  .amdhsa_user_sgpr_count 2
  .amdhsa_user_sgpr_kernarg_segment_ptr 1
  .amdhsa_system_sgpr_workgroup_id_x 1
.end_amdhsa_kernel

.p2align 6
.amdhsa_kernel standalone__edge_featured_mpnn_gatedgcn__graph_kernel
  .amdhsa_next_free_vgpr 128
  .amdhsa_next_free_sgpr 102
  .amdhsa_accum_offset 128
  .amdhsa_group_segment_fixed_size 0
  .amdhsa_kernarg_size 96
  .amdhsa_user_sgpr_count 2
  .amdhsa_user_sgpr_kernarg_segment_ptr 1
  .amdhsa_system_sgpr_workgroup_id_x 1
.end_amdhsa_kernel
```
